```python
import torch

def _softmax(x, axis=-1):
    return torch.softmax(x, dim=axis)
def _gelu(x):
    return torch.nn.functional.gelu(x, approximate="tanh")
def _silu(x):
    return torch.nn.functional.silu(x)
def _sigmoid(x):
    return torch.sigmoid(x)
def _layernorm(x, axis=-1, eps=1e-5):
    m = x.mean(dim=axis, keepdim=True)
    v = x.var(dim=axis, keepdim=True, unbiased=False)
    return (x - m) / torch.sqrt(v + eps)
def _scatter_add(tgt, idx, src, axis=0):
    return tgt.clone().index_add_(axis, idx, src)
def _segment_sum(src, seg, n):
    out = torch.zeros((n,) + src.shape[1:], dtype=src.dtype)
    return out.index_add_(0, seg, src)
def _pad(x, pw):
    flat = tuple(v for pair in reversed(pw) for v in pair)
    return torch.nn.functional.pad(x, flat)

kernel_name = 'standalone__mha_softmax__near_ridge'

def setup_inputs():

    _w = (lambda a: (lambda t: t.to(torch.bfloat16) if t.is_floating_point() else t)(torch.as_tensor(a)))
    B, H, Sq, Sk, D = 8, 32, 256, 512, 128
    return {
        "q": _w((lambda *s: torch.randn(*s, dtype=torch.bfloat16) * 0.8)(B, H, Sq, D)),
        "k": _w((lambda *s: torch.randn(*s, dtype=torch.bfloat16) * 0.8)(B, H, Sk, D)),
        "v": _w((lambda *s: torch.randn(*s, dtype=torch.bfloat16) * 0.05)(B, H, Sk, D)),
    }

def reference(q, k, v):
    scale = q.shape[-1] ** -0.5
    scores = torch.einsum("bhqd,bhkd->bhqk", q, k) * scale
    p = _softmax(scores, axis=-1)
    return torch.einsum("bhqk,bhkd->bhqd", p, v)
```

```asm
; @launch grid=(256,1,1) block=(256,1,1) lds=163840
.amdgcn_target "amdgcn-amd-amdhsa--gfx950"
.text
.globl standalone__mha_softmax__near_ridge_kernel
.p2align 8
.type standalone__mha_softmax__near_ridge_kernel,@function
standalone__mha_softmax__near_ridge_kernel:
    s_cmp_ge_u32 s2, 256
    s_cbranch_scc1 L_end
    s_load_dwordx4 s[4:7], s[0:1], 0
    s_load_dwordx4 s[8:11], s[0:1], 16
    v_lshrrev_b32 v241, 6, v0
    v_and_b32 v232, 63, v0
    v_readfirstlane_b32 s28, v241
    v_lshrrev_b32 v238, 4, v232
    v_and_b32 v239, 15, v232
    v_xor_b32 v240, v239, v238
    v_lshlrev_b32 v240, 4, v240
    v_lshl_or_b32 v242, v238, 8, v240
    v_xor_b32 v243, 64, v242
    v_xor_b32 v244, 128, v242
    v_xor_b32 v245, 192, v242
    s_lshl_b32 s29, s28, 11
    s_lshl_b32 s31, s2, 16
    s_lshl_b32 s38, s28, 14
    s_add_u32 s31, s31, s38
    s_add_u32 s38, s38, 65536
    s_and_b32 s39, s28, 1
    s_lshl_b32 s39, s39, 7
    v_xor_b32 v228, s39, v242
    v_xor_b32 v229, 64, v228
    s_lshl_b32 s40, s2, 17
    s_mov_b32 s18, 0x20000
    s_mov_b32 s19, 0x20000
    s_mov_b32 s14, 0x1000000
    s_mov_b32 s15, 0x20000
    s_add_u32 m0, s29, 131072
    s_add_u32 s34, s31, 4096
    s_add_u32 s35, s31, 8192
    s_add_u32 s36, s31, 12288
    s_waitcnt lgkmcnt(0)
    s_add_u32 s16, s6, s40
    s_addc_u32 s17, s7, 0
    s_and_b32 s17, s17, 0xffff
    s_mov_b32 s12, s4
    buffer_load_dwordx4 v228, s[16:19], s29 offen nt lds
    buffer_load_dwordx4 v229, s[16:19], s29 offen offset:1024 nt lds
    s_and_b32 s13, s5, 0xffff
    s_getpc_b64 s[64:65]
L_pc:
    s_sub_u32 s64, s64, L_pc-standalone__mha_softmax__near_ridge_kernel
    s_subb_u32 s65, s65, 0
    s_lshr_b32 s68, s2, 3
    s_and_b32 s68, s68, 7
    s_lshl_b32 s68, s68, 2
    s_add_u32 s68, s68, s28
    s_lshl_b32 s68, s68, 10
    v_lshl_add_u32 v208, v232, 4, s68
    v_min_u32 v208, L_slow-standalone__mha_softmax__near_ridge_kernel, v208
    v_mov_b32 v209, s65
    v_add_co_u32 v208, vcc, s64, v208
    s_nop 1
    v_addc_co_u32 v209, vcc, 0, v209, vcc
    global_load_dwordx4 v[212:215], v[208:209], off
    s_add_u32 m0, s38, 0
    s_nop 0
    buffer_load_dwordx4 v242, s[12:15], s31 offen nt lds
    buffer_load_dwordx4 v243, s[12:15], s31 offen offset:1024 nt lds
    buffer_load_dwordx4 v244, s[12:15], s31 offen offset:2048 nt lds
    buffer_load_dwordx4 v245, s[12:15], s31 offen offset:3072 nt lds
    s_add_u32 m0, s38, 4096
    s_nop 0
    buffer_load_dwordx4 v242, s[12:15], s34 offen nt lds
    buffer_load_dwordx4 v243, s[12:15], s34 offen offset:1024 nt lds
    buffer_load_dwordx4 v244, s[12:15], s34 offen offset:2048 nt lds
    buffer_load_dwordx4 v245, s[12:15], s34 offen offset:3072 nt lds
    s_add_u32 s20, s8, s40
    s_addc_u32 s21, s9, 0
    s_and_b32 s21, s21, 0xffff
    s_mov_b32 s22, 0x20000
    s_mov_b32 s23, 0x20000
    s_mov_b32 s24, s10
    s_and_b32 s25, s11, 0xffff
    s_mov_b32 s26, 0x1000000
    s_mov_b32 s27, 0x20000
    v_lshl_or_b32 v240, v239, 8, v240
    v_add_u32 v224, 0x20000, v240
    v_xor_b32 v225, 64, v224
    v_xor_b32 v226, 128, v224
    v_xor_b32 v227, 192, v224
    v_add_u32 v246, s38, v240
    v_xor_b32 v247, 64, v246
    v_xor_b32 v248, 128, v246
    v_xor_b32 v249, 192, v246
    v_and_b32 v239, 7, v232
    v_lshlrev_b32 v240, 1, v238
    v_xor_b32 v240, v239, v240
    v_lshlrev_b32 v240, 4, v240
    v_lshrrev_b32 v241, 3, v232
    v_lshl_or_b32 v230, v241, 8, v240
    v_add_u32 v231, 0x400, v230
    s_lshl_b32 s30, s28, 12
    v_and_b32 v239, 3, v232
    v_min_u32 v239, 1, v239
    v_subrev_u32 v239, 1, v239
    v_and_b32 v239, 0x3f803f80, v239
    v_accvgpr_write_b32 a208, v239
    v_accvgpr_write_b32 a209, v239
    v_accvgpr_write_b32 a210, v239
    v_accvgpr_write_b32 a211, v239
    s_mov_b32 s32, 0x3e0293ee
    s_mov_b32 s33, 0x3e0293ee
    s_mov_b32 s41, 0x5d800000
    s_lshl_b32 s43, s28, 13
    s_add_u32 s43, s43, 131072
    s_add_u32 m0, s38, 8192
    s_nop 0
    buffer_load_dwordx4 v242, s[12:15], s35 offen nt lds
    buffer_load_dwordx4 v243, s[12:15], s35 offen offset:1024 nt lds
    buffer_load_dwordx4 v244, s[12:15], s35 offen offset:2048 nt lds
    buffer_load_dwordx4 v245, s[12:15], s35 offen offset:3072 nt lds
    s_add_u32 m0, s38, 12288
    s_nop 0
    buffer_load_dwordx4 v242, s[12:15], s36 offen nt lds
    buffer_load_dwordx4 v243, s[12:15], s36 offen offset:1024 nt lds
    buffer_load_dwordx4 v244, s[12:15], s36 offen offset:2048 nt lds
    buffer_load_dwordx4 v245, s[12:15], s36 offen offset:3072 nt lds
    s_waitcnt vmcnt(17)
    s_barrier
    ds_read_b128 a[64:67], v224 offset:0
    ds_read_b128 a[68:71], v225 offset:0
    ds_read_b128 a[72:75], v226 offset:0
    ds_read_b128 a[76:79], v227 offset:0
    ds_read_b128 a[80:83], v224 offset:4096
    ds_read_b128 a[84:87], v225 offset:4096
    ds_read_b128 a[88:91], v226 offset:4096
    ds_read_b128 a[92:95], v227 offset:4096
    s_waitcnt vmcnt(12)
    ds_read_b128 v[0:3], v246 offset:0
    ds_read_b128 v[4:7], v247 offset:0
    ds_read_b128 v[8:11], v248 offset:0
    ds_read_b128 v[12:15], v249 offset:0
    s_waitcnt lgkmcnt(3)
    v_lshlrev_b32 v16, 16, v0
    v_and_b32 v17, 0xffff0000, v0
    v_pk_mul_f32 v[16:17], v[16:17], s[32:33]
    v_cvt_pk_bf16_f32 v16, v16, v17
    v_accvgpr_write_b32 a0, v16
    v_lshlrev_b32 v18, 16, v1
    v_and_b32 v19, 0xffff0000, v1
    v_pk_mul_f32 v[18:19], v[18:19], s[32:33]
    v_cvt_pk_bf16_f32 v18, v18, v19
    v_accvgpr_write_b32 a1, v18
    v_lshlrev_b32 v20, 16, v2
    v_and_b32 v21, 0xffff0000, v2
    v_pk_mul_f32 v[20:21], v[20:21], s[32:33]
    v_cvt_pk_bf16_f32 v20, v20, v21
    v_accvgpr_write_b32 a2, v20
    v_lshlrev_b32 v22, 16, v3
    v_and_b32 v23, 0xffff0000, v3
    v_pk_mul_f32 v[22:23], v[22:23], s[32:33]
    v_cvt_pk_bf16_f32 v22, v22, v23
    v_accvgpr_write_b32 a3, v22
    s_waitcnt lgkmcnt(2)
    v_lshlrev_b32 v16, 16, v4
    v_and_b32 v17, 0xffff0000, v4
    v_pk_mul_f32 v[16:17], v[16:17], s[32:33]
    v_cvt_pk_bf16_f32 v16, v16, v17
    v_accvgpr_write_b32 a4, v16
    v_lshlrev_b32 v18, 16, v5
    v_and_b32 v19, 0xffff0000, v5
    v_pk_mul_f32 v[18:19], v[18:19], s[32:33]
    v_cvt_pk_bf16_f32 v18, v18, v19
    v_accvgpr_write_b32 a5, v18
    v_lshlrev_b32 v20, 16, v6
    v_and_b32 v21, 0xffff0000, v6
    v_pk_mul_f32 v[20:21], v[20:21], s[32:33]
    v_cvt_pk_bf16_f32 v20, v20, v21
    v_accvgpr_write_b32 a6, v20
    v_lshlrev_b32 v22, 16, v7
    v_and_b32 v23, 0xffff0000, v7
    v_pk_mul_f32 v[22:23], v[22:23], s[32:33]
    v_cvt_pk_bf16_f32 v22, v22, v23
    v_accvgpr_write_b32 a7, v22
    s_waitcnt lgkmcnt(1)
    v_lshlrev_b32 v16, 16, v8
    v_and_b32 v17, 0xffff0000, v8
    v_pk_mul_f32 v[16:17], v[16:17], s[32:33]
    v_cvt_pk_bf16_f32 v16, v16, v17
    v_accvgpr_write_b32 a8, v16
    v_lshlrev_b32 v18, 16, v9
    v_and_b32 v19, 0xffff0000, v9
    v_pk_mul_f32 v[18:19], v[18:19], s[32:33]
    v_cvt_pk_bf16_f32 v18, v18, v19
    v_accvgpr_write_b32 a9, v18
    v_lshlrev_b32 v20, 16, v10
    v_and_b32 v21, 0xffff0000, v10
    v_pk_mul_f32 v[20:21], v[20:21], s[32:33]
    v_cvt_pk_bf16_f32 v20, v20, v21
    v_accvgpr_write_b32 a10, v20
    v_lshlrev_b32 v22, 16, v11
    v_and_b32 v23, 0xffff0000, v11
    v_pk_mul_f32 v[22:23], v[22:23], s[32:33]
    v_cvt_pk_bf16_f32 v22, v22, v23
    v_accvgpr_write_b32 a11, v22
    s_waitcnt lgkmcnt(0)
    v_lshlrev_b32 v16, 16, v12
    v_and_b32 v17, 0xffff0000, v12
    v_pk_mul_f32 v[16:17], v[16:17], s[32:33]
    v_cvt_pk_bf16_f32 v16, v16, v17
    v_accvgpr_write_b32 a12, v16
    v_lshlrev_b32 v18, 16, v13
    v_and_b32 v19, 0xffff0000, v13
    v_pk_mul_f32 v[18:19], v[18:19], s[32:33]
    v_cvt_pk_bf16_f32 v18, v18, v19
    v_accvgpr_write_b32 a13, v18
    v_lshlrev_b32 v20, 16, v14
    v_and_b32 v21, 0xffff0000, v14
    v_pk_mul_f32 v[20:21], v[20:21], s[32:33]
    v_cvt_pk_bf16_f32 v20, v20, v21
    v_accvgpr_write_b32 a14, v20
    v_lshlrev_b32 v22, 16, v15
    v_and_b32 v23, 0xffff0000, v15
    v_pk_mul_f32 v[22:23], v[22:23], s[32:33]
    v_cvt_pk_bf16_f32 v22, v22, v23
    v_accvgpr_write_b32 a15, v22
    s_nop 1
    v_mfma_f32_16x16x32_bf16 v[160:163], a[64:67], a[0:3], 0
    v_mfma_f32_16x16x32_bf16 v[160:163], a[68:71], a[4:7], v[160:163]
    v_mfma_f32_16x16x32_bf16 v[160:163], a[72:75], a[8:11], v[160:163]
    v_mfma_f32_16x16x32_bf16 v[160:163], a[76:79], a[12:15], v[160:163]
    s_add_u32 m0, s29, 139264
    s_add_u32 s39, s29, 8192
    buffer_load_dwordx4 v228, s[16:19], s39 offen nt lds
    v_mfma_f32_16x16x32_bf16 v[176:179], a[80:83], a[0:3], 0
    v_mfma_f32_16x16x32_bf16 v[176:179], a[84:87], a[4:7], v[176:179]
    v_mfma_f32_16x16x32_bf16 v[176:179], a[88:91], a[8:11], v[176:179]
    v_mfma_f32_16x16x32_bf16 v[176:179], a[92:95], a[12:15], v[176:179]
    buffer_load_dwordx4 v229, s[16:19], s39 offen offset:1024 nt lds
    s_waitcnt vmcnt(10)
    ds_read_b128 v[0:3], v246 offset:4096
    ds_read_b128 v[4:7], v247 offset:4096
    ds_read_b128 v[8:11], v248 offset:4096
    ds_read_b128 v[12:15], v249 offset:4096
    s_nop 2
    v_max3_f32 v238, v160, v161, v162
    v_max3_f32 v239, v176, v177, v178
    v_max3_f32 v238, v238, v163, v179
    v_max_f32 v238, v238, v239
    v_mov_b32 v239, v238
    s_nop 1
    v_permlane16_swap_b32 v238, v239
    s_nop 0
    v_max_f32 v238, v238, v239
    v_mov_b32 v239, v238
    s_nop 1
    v_permlane32_swap_b32 v238, v239
    s_nop 0
    v_max_f32 v238, v238, v239
    v_sub_f32 v160, v160, v238
    v_sub_f32 v161, v161, v238
    v_sub_f32 v162, v162, v238
    v_sub_f32 v163, v163, v238
    v_sub_f32 v176, v176, v238
    v_sub_f32 v177, v177, v238
    v_sub_f32 v178, v178, v238
    v_sub_f32 v179, v179, v238
    v_sub_f32 v192, 0, v238
    v_sub_f32 v193, 0, v238
    v_sub_f32 v194, 0, v238
    v_sub_f32 v195, 0, v238
    v_sub_f32 v234, 0, v238
    v_exp_f32 v160, v160
    v_exp_f32 v161, v161
    v_exp_f32 v162, v162
    v_exp_f32 v163, v163
    v_cvt_pk_bf16_f32 v208, v160, v161
    v_accvgpr_write_b32 a96, v208
    v_cvt_pk_bf16_f32 v209, v162, v163
    v_accvgpr_write_b32 a97, v209
    v_exp_f32 v176, v176
    v_exp_f32 v177, v177
    v_exp_f32 v178, v178
    v_exp_f32 v179, v179
    v_cvt_pk_bf16_f32 v208, v176, v177
    v_accvgpr_write_b32 a98, v208
    v_cvt_pk_bf16_f32 v209, v178, v179
    v_accvgpr_write_b32 a99, v209
    s_nop 1
    v_mfma_f32_16x16x32_bf16 a[192:195], a[208:211], a[96:99], 0
    s_waitcnt lgkmcnt(3)
    v_lshlrev_b32 v16, 16, v0
    v_and_b32 v17, 0xffff0000, v0
    v_pk_mul_f32 v[16:17], v[16:17], s[32:33]
    v_cvt_pk_bf16_f32 v16, v16, v17
    v_accvgpr_write_b32 a16, v16
    v_lshlrev_b32 v18, 16, v1
    v_and_b32 v19, 0xffff0000, v1
    v_pk_mul_f32 v[18:19], v[18:19], s[32:33]
    v_cvt_pk_bf16_f32 v18, v18, v19
    v_accvgpr_write_b32 a17, v18
    v_lshlrev_b32 v20, 16, v2
    v_and_b32 v21, 0xffff0000, v2
    v_pk_mul_f32 v[20:21], v[20:21], s[32:33]
    v_cvt_pk_bf16_f32 v20, v20, v21
    v_accvgpr_write_b32 a18, v20
    v_lshlrev_b32 v22, 16, v3
    v_and_b32 v23, 0xffff0000, v3
    v_pk_mul_f32 v[22:23], v[22:23], s[32:33]
    v_cvt_pk_bf16_f32 v22, v22, v23
    v_accvgpr_write_b32 a19, v22
    s_waitcnt lgkmcnt(2)
    v_lshlrev_b32 v16, 16, v4
    v_and_b32 v17, 0xffff0000, v4
    v_pk_mul_f32 v[16:17], v[16:17], s[32:33]
    v_cvt_pk_bf16_f32 v16, v16, v17
    v_accvgpr_write_b32 a20, v16
    v_lshlrev_b32 v18, 16, v5
    v_and_b32 v19, 0xffff0000, v5
    v_pk_mul_f32 v[18:19], v[18:19], s[32:33]
    v_cvt_pk_bf16_f32 v18, v18, v19
    v_accvgpr_write_b32 a21, v18
    v_lshlrev_b32 v20, 16, v6
    v_and_b32 v21, 0xffff0000, v6
    v_pk_mul_f32 v[20:21], v[20:21], s[32:33]
    v_cvt_pk_bf16_f32 v20, v20, v21
    v_accvgpr_write_b32 a22, v20
    v_lshlrev_b32 v22, 16, v7
    v_and_b32 v23, 0xffff0000, v7
    v_pk_mul_f32 v[22:23], v[22:23], s[32:33]
    v_cvt_pk_bf16_f32 v22, v22, v23
    v_accvgpr_write_b32 a23, v22
    s_waitcnt lgkmcnt(1)
    v_lshlrev_b32 v16, 16, v8
    v_and_b32 v17, 0xffff0000, v8
    v_pk_mul_f32 v[16:17], v[16:17], s[32:33]
    v_cvt_pk_bf16_f32 v16, v16, v17
    v_accvgpr_write_b32 a24, v16
    v_lshlrev_b32 v18, 16, v9
    v_and_b32 v19, 0xffff0000, v9
    v_pk_mul_f32 v[18:19], v[18:19], s[32:33]
    v_cvt_pk_bf16_f32 v18, v18, v19
    v_accvgpr_write_b32 a25, v18
    v_lshlrev_b32 v20, 16, v10
    v_and_b32 v21, 0xffff0000, v10
    v_pk_mul_f32 v[20:21], v[20:21], s[32:33]
    v_cvt_pk_bf16_f32 v20, v20, v21
    v_accvgpr_write_b32 a26, v20
    v_lshlrev_b32 v22, 16, v11
    v_and_b32 v23, 0xffff0000, v11
    v_pk_mul_f32 v[22:23], v[22:23], s[32:33]
    v_cvt_pk_bf16_f32 v22, v22, v23
    v_accvgpr_write_b32 a27, v22
    s_waitcnt lgkmcnt(0)
    v_lshlrev_b32 v16, 16, v12
    v_and_b32 v17, 0xffff0000, v12
    v_pk_mul_f32 v[16:17], v[16:17], s[32:33]
    v_cvt_pk_bf16_f32 v16, v16, v17
    v_accvgpr_write_b32 a28, v16
    v_lshlrev_b32 v18, 16, v13
    v_and_b32 v19, 0xffff0000, v13
    v_pk_mul_f32 v[18:19], v[18:19], s[32:33]
    v_cvt_pk_bf16_f32 v18, v18, v19
    v_accvgpr_write_b32 a29, v18
    v_lshlrev_b32 v20, 16, v14
    v_and_b32 v21, 0xffff0000, v14
    v_pk_mul_f32 v[20:21], v[20:21], s[32:33]
    v_cvt_pk_bf16_f32 v20, v20, v21
    v_accvgpr_write_b32 a30, v20
    v_lshlrev_b32 v22, 16, v15
    v_and_b32 v23, 0xffff0000, v15
    v_pk_mul_f32 v[22:23], v[22:23], s[32:33]
    v_cvt_pk_bf16_f32 v22, v22, v23
    v_accvgpr_write_b32 a31, v22
    s_nop 1
    v_mfma_f32_16x16x32_bf16 v[164:167], a[64:67], a[16:19], 0
    v_mfma_f32_16x16x32_bf16 v[164:167], a[68:71], a[20:23], v[164:167]
    v_mfma_f32_16x16x32_bf16 v[164:167], a[72:75], a[24:27], v[164:167]
    v_mfma_f32_16x16x32_bf16 v[164:167], a[76:79], a[28:31], v[164:167]
    s_add_u32 m0, s29, 147456
    s_add_u32 s39, s29, 16384
    buffer_load_dwordx4 v228, s[16:19], s39 offen nt lds
    v_mfma_f32_16x16x32_bf16 v[180:183], a[80:83], a[16:19], 0
    v_mfma_f32_16x16x32_bf16 v[180:183], a[84:87], a[20:23], v[180:183]
    v_mfma_f32_16x16x32_bf16 v[180:183], a[88:91], a[24:27], v[180:183]
    v_mfma_f32_16x16x32_bf16 v[180:183], a[92:95], a[28:31], v[180:183]
    buffer_load_dwordx4 v229, s[16:19], s39 offen offset:1024 nt lds
    s_waitcnt vmcnt(8)
    ds_read_b128 v[0:3], v246 offset:8192
    ds_read_b128 v[4:7], v247 offset:8192
    ds_read_b128 v[8:11], v248 offset:8192
    ds_read_b128 v[12:15], v249 offset:8192
    s_nop 2
    v_max3_f32 v238, v164, v165, v166
    v_max3_f32 v239, v180, v181, v182
    v_max3_f32 v238, v238, v167, v183
    v_max_f32 v238, v238, v239
    v_mov_b32 v239, v238
    s_nop 1
    v_permlane16_swap_b32 v238, v239
    s_nop 0
    v_max_f32 v238, v238, v239
    v_mov_b32 v239, v238
    s_nop 1
    v_permlane32_swap_b32 v238, v239
    s_nop 0
    v_max_f32 v238, v238, v239
    v_sub_f32 v164, v164, v238
    v_sub_f32 v165, v165, v238
    v_sub_f32 v166, v166, v238
    v_sub_f32 v167, v167, v238
    v_sub_f32 v180, v180, v238
    v_sub_f32 v181, v181, v238
    v_sub_f32 v182, v182, v238
    v_sub_f32 v183, v183, v238
    v_sub_f32 v196, 0, v238
    v_sub_f32 v197, 0, v238
    v_sub_f32 v198, 0, v238
    v_sub_f32 v199, 0, v238
    v_sub_f32 v235, 0, v238
    v_exp_f32 v164, v164
    v_exp_f32 v165, v165
    v_exp_f32 v166, v166
    v_exp_f32 v167, v167
    v_cvt_pk_bf16_f32 v210, v164, v165
    v_accvgpr_write_b32 a100, v210
    v_cvt_pk_bf16_f32 v211, v166, v167
    v_accvgpr_write_b32 a101, v211
    v_exp_f32 v180, v180
    v_exp_f32 v181, v181
    v_exp_f32 v182, v182
    v_exp_f32 v183, v183
    v_cvt_pk_bf16_f32 v210, v180, v181
    v_accvgpr_write_b32 a102, v210
    v_cvt_pk_bf16_f32 v211, v182, v183
    v_accvgpr_write_b32 a103, v211
    s_nop 1
    v_mfma_f32_16x16x32_bf16 a[196:199], a[208:211], a[100:103], 0
    s_waitcnt lgkmcnt(3)
    v_lshlrev_b32 v16, 16, v0
    v_and_b32 v17, 0xffff0000, v0
    v_pk_mul_f32 v[16:17], v[16:17], s[32:33]
    v_cvt_pk_bf16_f32 v16, v16, v17
    v_accvgpr_write_b32 a32, v16
    v_lshlrev_b32 v18, 16, v1
    v_and_b32 v19, 0xffff0000, v1
    v_pk_mul_f32 v[18:19], v[18:19], s[32:33]
    v_cvt_pk_bf16_f32 v18, v18, v19
    v_accvgpr_write_b32 a33, v18
    v_lshlrev_b32 v20, 16, v2
    v_and_b32 v21, 0xffff0000, v2
    v_pk_mul_f32 v[20:21], v[20:21], s[32:33]
    v_cvt_pk_bf16_f32 v20, v20, v21
    v_accvgpr_write_b32 a34, v20
    v_lshlrev_b32 v22, 16, v3
    v_and_b32 v23, 0xffff0000, v3
    v_pk_mul_f32 v[22:23], v[22:23], s[32:33]
    v_cvt_pk_bf16_f32 v22, v22, v23
    v_accvgpr_write_b32 a35, v22
    s_waitcnt lgkmcnt(2)
    v_lshlrev_b32 v16, 16, v4
    v_and_b32 v17, 0xffff0000, v4
    v_pk_mul_f32 v[16:17], v[16:17], s[32:33]
    v_cvt_pk_bf16_f32 v16, v16, v17
    v_accvgpr_write_b32 a36, v16
    v_lshlrev_b32 v18, 16, v5
    v_and_b32 v19, 0xffff0000, v5
    v_pk_mul_f32 v[18:19], v[18:19], s[32:33]
    v_cvt_pk_bf16_f32 v18, v18, v19
    v_accvgpr_write_b32 a37, v18
    v_lshlrev_b32 v20, 16, v6
    v_and_b32 v21, 0xffff0000, v6
    v_pk_mul_f32 v[20:21], v[20:21], s[32:33]
    v_cvt_pk_bf16_f32 v20, v20, v21
    v_accvgpr_write_b32 a38, v20
    v_lshlrev_b32 v22, 16, v7
    v_and_b32 v23, 0xffff0000, v7
    v_pk_mul_f32 v[22:23], v[22:23], s[32:33]
    v_cvt_pk_bf16_f32 v22, v22, v23
    v_accvgpr_write_b32 a39, v22
    s_waitcnt lgkmcnt(1)
    v_lshlrev_b32 v16, 16, v8
    v_and_b32 v17, 0xffff0000, v8
    v_pk_mul_f32 v[16:17], v[16:17], s[32:33]
    v_cvt_pk_bf16_f32 v16, v16, v17
    v_accvgpr_write_b32 a40, v16
    v_lshlrev_b32 v18, 16, v9
    v_and_b32 v19, 0xffff0000, v9
    v_pk_mul_f32 v[18:19], v[18:19], s[32:33]
    v_cvt_pk_bf16_f32 v18, v18, v19
    v_accvgpr_write_b32 a41, v18
    v_lshlrev_b32 v20, 16, v10
    v_and_b32 v21, 0xffff0000, v10
    v_pk_mul_f32 v[20:21], v[20:21], s[32:33]
    v_cvt_pk_bf16_f32 v20, v20, v21
    v_accvgpr_write_b32 a42, v20
    v_lshlrev_b32 v22, 16, v11
    v_and_b32 v23, 0xffff0000, v11
    v_pk_mul_f32 v[22:23], v[22:23], s[32:33]
    v_cvt_pk_bf16_f32 v22, v22, v23
    v_accvgpr_write_b32 a43, v22
    s_waitcnt lgkmcnt(0)
    v_lshlrev_b32 v16, 16, v12
    v_and_b32 v17, 0xffff0000, v12
    v_pk_mul_f32 v[16:17], v[16:17], s[32:33]
    v_cvt_pk_bf16_f32 v16, v16, v17
    v_accvgpr_write_b32 a44, v16
    v_lshlrev_b32 v18, 16, v13
    v_and_b32 v19, 0xffff0000, v13
    v_pk_mul_f32 v[18:19], v[18:19], s[32:33]
    v_cvt_pk_bf16_f32 v18, v18, v19
    v_accvgpr_write_b32 a45, v18
    v_lshlrev_b32 v20, 16, v14
    v_and_b32 v21, 0xffff0000, v14
    v_pk_mul_f32 v[20:21], v[20:21], s[32:33]
    v_cvt_pk_bf16_f32 v20, v20, v21
    v_accvgpr_write_b32 a46, v20
    v_lshlrev_b32 v22, 16, v15
    v_and_b32 v23, 0xffff0000, v15
    v_pk_mul_f32 v[22:23], v[22:23], s[32:33]
    v_cvt_pk_bf16_f32 v22, v22, v23
    v_accvgpr_write_b32 a47, v22
    s_nop 1
    v_mfma_f32_16x16x32_bf16 v[168:171], a[64:67], a[32:35], 0
    v_mfma_f32_16x16x32_bf16 v[168:171], a[68:71], a[36:39], v[168:171]
    v_mfma_f32_16x16x32_bf16 v[168:171], a[72:75], a[40:43], v[168:171]
    v_mfma_f32_16x16x32_bf16 v[168:171], a[76:79], a[44:47], v[168:171]
    s_add_u32 m0, s29, 155648
    s_add_u32 s39, s29, 24576
    buffer_load_dwordx4 v228, s[16:19], s39 offen nt lds
    v_mfma_f32_16x16x32_bf16 v[184:187], a[80:83], a[32:35], 0
    v_mfma_f32_16x16x32_bf16 v[184:187], a[84:87], a[36:39], v[184:187]
    v_mfma_f32_16x16x32_bf16 v[184:187], a[88:91], a[40:43], v[184:187]
    v_mfma_f32_16x16x32_bf16 v[184:187], a[92:95], a[44:47], v[184:187]
    buffer_load_dwordx4 v229, s[16:19], s39 offen offset:1024 nt lds
    s_waitcnt vmcnt(6)
    ds_read_b128 v[0:3], v246 offset:12288
    ds_read_b128 v[4:7], v247 offset:12288
    ds_read_b128 v[8:11], v248 offset:12288
    ds_read_b128 v[12:15], v249 offset:12288
    s_nop 2
    v_max3_f32 v238, v168, v169, v170
    v_max3_f32 v239, v184, v185, v186
    v_max3_f32 v238, v238, v171, v187
    v_max_f32 v238, v238, v239
    v_mov_b32 v239, v238
    s_nop 1
    v_permlane16_swap_b32 v238, v239
    s_nop 0
    v_max_f32 v238, v238, v239
    v_mov_b32 v239, v238
    s_nop 1
    v_permlane32_swap_b32 v238, v239
    s_nop 0
    v_max_f32 v238, v238, v239
    v_sub_f32 v168, v168, v238
    v_sub_f32 v169, v169, v238
    v_sub_f32 v170, v170, v238
    v_sub_f32 v171, v171, v238
    v_sub_f32 v184, v184, v238
    v_sub_f32 v185, v185, v238
    v_sub_f32 v186, v186, v238
    v_sub_f32 v187, v187, v238
    v_sub_f32 v200, 0, v238
    v_sub_f32 v201, 0, v238
    v_sub_f32 v202, 0, v238
    v_sub_f32 v203, 0, v238
    v_sub_f32 v236, 0, v238
    v_exp_f32 v168, v168
    v_exp_f32 v169, v169
    v_exp_f32 v170, v170
    v_exp_f32 v171, v171
    v_cvt_pk_bf16_f32 v208, v168, v169
    v_accvgpr_write_b32 a104, v208
    v_cvt_pk_bf16_f32 v209, v170, v171
    v_accvgpr_write_b32 a105, v209
    v_exp_f32 v184, v184
    v_exp_f32 v185, v185
    v_exp_f32 v186, v186
    v_exp_f32 v187, v187
    v_cvt_pk_bf16_f32 v208, v184, v185
    v_accvgpr_write_b32 a106, v208
    v_cvt_pk_bf16_f32 v209, v186, v187
    v_accvgpr_write_b32 a107, v209
    s_nop 1
    v_mfma_f32_16x16x32_bf16 a[200:203], a[208:211], a[104:107], 0
    s_waitcnt lgkmcnt(3)
    v_lshlrev_b32 v16, 16, v0
    v_and_b32 v17, 0xffff0000, v0
    v_pk_mul_f32 v[16:17], v[16:17], s[32:33]
    v_cvt_pk_bf16_f32 v16, v16, v17
    v_accvgpr_write_b32 a48, v16
    v_lshlrev_b32 v18, 16, v1
    v_and_b32 v19, 0xffff0000, v1
    v_pk_mul_f32 v[18:19], v[18:19], s[32:33]
    v_cvt_pk_bf16_f32 v18, v18, v19
    v_accvgpr_write_b32 a49, v18
    v_lshlrev_b32 v20, 16, v2
    v_and_b32 v21, 0xffff0000, v2
    v_pk_mul_f32 v[20:21], v[20:21], s[32:33]
    v_cvt_pk_bf16_f32 v20, v20, v21
    v_accvgpr_write_b32 a50, v20
    v_lshlrev_b32 v22, 16, v3
    v_and_b32 v23, 0xffff0000, v3
    v_pk_mul_f32 v[22:23], v[22:23], s[32:33]
    v_cvt_pk_bf16_f32 v22, v22, v23
    v_accvgpr_write_b32 a51, v22
    s_waitcnt lgkmcnt(2)
    v_lshlrev_b32 v16, 16, v4
    v_and_b32 v17, 0xffff0000, v4
    v_pk_mul_f32 v[16:17], v[16:17], s[32:33]
    v_cvt_pk_bf16_f32 v16, v16, v17
    v_accvgpr_write_b32 a52, v16
    v_lshlrev_b32 v18, 16, v5
    v_and_b32 v19, 0xffff0000, v5
    v_pk_mul_f32 v[18:19], v[18:19], s[32:33]
    v_cvt_pk_bf16_f32 v18, v18, v19
    v_accvgpr_write_b32 a53, v18
    v_lshlrev_b32 v20, 16, v6
    v_and_b32 v21, 0xffff0000, v6
    v_pk_mul_f32 v[20:21], v[20:21], s[32:33]
    v_cvt_pk_bf16_f32 v20, v20, v21
    v_accvgpr_write_b32 a54, v20
    v_lshlrev_b32 v22, 16, v7
    v_and_b32 v23, 0xffff0000, v7
    v_pk_mul_f32 v[22:23], v[22:23], s[32:33]
    v_cvt_pk_bf16_f32 v22, v22, v23
    v_accvgpr_write_b32 a55, v22
    s_waitcnt lgkmcnt(1)
    v_lshlrev_b32 v16, 16, v8
    v_and_b32 v17, 0xffff0000, v8
    v_pk_mul_f32 v[16:17], v[16:17], s[32:33]
    v_cvt_pk_bf16_f32 v16, v16, v17
    v_accvgpr_write_b32 a56, v16
    v_lshlrev_b32 v18, 16, v9
    v_and_b32 v19, 0xffff0000, v9
    v_pk_mul_f32 v[18:19], v[18:19], s[32:33]
    v_cvt_pk_bf16_f32 v18, v18, v19
    v_accvgpr_write_b32 a57, v18
    v_lshlrev_b32 v20, 16, v10
    v_and_b32 v21, 0xffff0000, v10
    v_pk_mul_f32 v[20:21], v[20:21], s[32:33]
    v_cvt_pk_bf16_f32 v20, v20, v21
    v_accvgpr_write_b32 a58, v20
    v_lshlrev_b32 v22, 16, v11
    v_and_b32 v23, 0xffff0000, v11
    v_pk_mul_f32 v[22:23], v[22:23], s[32:33]
    v_cvt_pk_bf16_f32 v22, v22, v23
    v_accvgpr_write_b32 a59, v22
    s_waitcnt lgkmcnt(0)
    v_lshlrev_b32 v16, 16, v12
    v_and_b32 v17, 0xffff0000, v12
    v_pk_mul_f32 v[16:17], v[16:17], s[32:33]
    v_cvt_pk_bf16_f32 v16, v16, v17
    v_accvgpr_write_b32 a60, v16
    v_lshlrev_b32 v18, 16, v13
    v_and_b32 v19, 0xffff0000, v13
    v_pk_mul_f32 v[18:19], v[18:19], s[32:33]
    v_cvt_pk_bf16_f32 v18, v18, v19
    v_accvgpr_write_b32 a61, v18
    v_lshlrev_b32 v20, 16, v14
    v_and_b32 v21, 0xffff0000, v14
    v_pk_mul_f32 v[20:21], v[20:21], s[32:33]
    v_cvt_pk_bf16_f32 v20, v20, v21
    v_accvgpr_write_b32 a62, v20
    v_lshlrev_b32 v22, 16, v15
    v_and_b32 v23, 0xffff0000, v15
    v_pk_mul_f32 v[22:23], v[22:23], s[32:33]
    v_cvt_pk_bf16_f32 v22, v22, v23
    v_accvgpr_write_b32 a63, v22
    s_nop 1
    v_mfma_f32_16x16x32_bf16 v[172:175], a[64:67], a[48:51], 0
    v_mfma_f32_16x16x32_bf16 v[172:175], a[68:71], a[52:55], v[172:175]
    v_mfma_f32_16x16x32_bf16 v[172:175], a[72:75], a[56:59], v[172:175]
    v_mfma_f32_16x16x32_bf16 v[172:175], a[76:79], a[60:63], v[172:175]
    v_mfma_f32_16x16x32_bf16 v[188:191], a[80:83], a[48:51], 0
    v_mfma_f32_16x16x32_bf16 v[188:191], a[84:87], a[52:55], v[188:191]
    v_mfma_f32_16x16x32_bf16 v[188:191], a[88:91], a[56:59], v[188:191]
    v_mfma_f32_16x16x32_bf16 v[188:191], a[92:95], a[60:63], v[188:191]
    s_waitcnt vmcnt(4)
    s_barrier
    ds_read_b128 a[64:67], v224 offset:8192
    ds_read_b128 a[68:71], v225 offset:8192
    ds_read_b128 a[72:75], v226 offset:8192
    ds_read_b128 a[76:79], v227 offset:8192
    ds_read_b128 a[80:83], v224 offset:12288
    ds_read_b128 a[84:87], v225 offset:12288
    ds_read_b128 a[88:91], v226 offset:12288
    ds_read_b128 a[92:95], v227 offset:12288
    v_max3_f32 v238, v172, v173, v174
    v_max3_f32 v239, v188, v189, v190
    v_max3_f32 v238, v238, v175, v191
    v_max_f32 v238, v238, v239
    v_mov_b32 v239, v238
    s_nop 1
    v_permlane16_swap_b32 v238, v239
    s_nop 0
    v_max_f32 v238, v238, v239
    v_mov_b32 v239, v238
    s_nop 1
    v_permlane32_swap_b32 v238, v239
    s_nop 0
    v_max_f32 v238, v238, v239
    v_sub_f32 v172, v172, v238
    v_sub_f32 v173, v173, v238
    v_sub_f32 v174, v174, v238
    v_sub_f32 v175, v175, v238
    v_sub_f32 v188, v188, v238
    v_sub_f32 v189, v189, v238
    v_sub_f32 v190, v190, v238
    v_sub_f32 v191, v191, v238
    v_sub_f32 v204, 0, v238
    v_sub_f32 v205, 0, v238
    v_sub_f32 v206, 0, v238
    v_sub_f32 v207, 0, v238
    v_sub_f32 v237, 0, v238
    s_waitcnt lgkmcnt(4)
    v_mfma_f32_16x16x32_bf16 v[160:163], a[64:67], a[0:3], v[192:195]
    v_exp_f32 v172, v172
    v_mfma_f32_16x16x32_bf16 v[160:163], a[68:71], a[4:7], v[160:163]
    v_exp_f32 v173, v173
    v_mfma_f32_16x16x32_bf16 v[160:163], a[72:75], a[8:11], v[160:163]
    v_exp_f32 v174, v174
    v_mfma_f32_16x16x32_bf16 v[160:163], a[76:79], a[12:15], v[160:163]
    s_add_u32 m0, s29, 65536
    v_exp_f32 v175, v175
    v_mfma_f32_16x16x32_bf16 v[164:167], a[64:67], a[16:19], v[196:199]
    s_add_u32 s39, s29, 32768
    v_cvt_pk_bf16_f32 v210, v172, v173
    v_accvgpr_write_b32 a108, v210
    v_mfma_f32_16x16x32_bf16 v[164:167], a[68:71], a[20:23], v[164:167]
    buffer_load_dwordx4 v228, s[16:19], s39 offen nt lds
    v_mfma_f32_16x16x32_bf16 v[164:167], a[72:75], a[24:27], v[164:167]
    buffer_load_dwordx4 v229, s[16:19], s39 offen offset:1024 nt lds
    v_mfma_f32_16x16x32_bf16 v[164:167], a[76:79], a[28:31], v[164:167]
    v_cvt_pk_bf16_f32 v211, v174, v175
    v_accvgpr_write_b32 a109, v211
    v_mfma_f32_16x16x32_bf16 v[168:171], a[64:67], a[32:35], v[200:203]
    v_exp_f32 v188, v188
    v_mfma_f32_16x16x32_bf16 v[168:171], a[68:71], a[36:39], v[168:171]
    v_exp_f32 v189, v189
    v_exp_f32 v190, v190
    v_exp_f32 v191, v191
    v_cvt_pk_bf16_f32 v210, v188, v189
    v_accvgpr_write_b32 a110, v210
    v_cvt_pk_bf16_f32 v211, v190, v191
    v_accvgpr_write_b32 a111, v211
    v_mfma_f32_16x16x32_bf16 v[168:171], a[72:75], a[40:43], v[168:171]
    s_waitcnt vmcnt(4)
    s_barrier
    v_exp_f32 v160, v160
    v_mfma_f32_16x16x32_bf16 a[204:207], a[208:211], a[108:111], 0
    v_exp_f32 v161, v161
    v_mfma_f32_16x16x32_bf16 v[168:171], a[76:79], a[44:47], v[168:171]
    v_exp_f32 v162, v162
    v_mfma_f32_16x16x32_bf16 v[172:175], a[64:67], a[48:51], v[204:207]
    v_exp_f32 v163, v163
    v_mfma_f32_16x16x32_bf16 v[172:175], a[68:71], a[52:55], v[172:175]
    s_waitcnt lgkmcnt(0)
    v_cvt_pk_bf16_f32 v208, v160, v161
    v_accvgpr_write_b32 a112, v208
    v_mfma_f32_16x16x32_bf16 v[172:175], a[72:75], a[56:59], v[172:175]
    v_cvt_pk_bf16_f32 v209, v162, v163
    v_accvgpr_write_b32 a113, v209
    v_mfma_f32_16x16x32_bf16 v[172:175], a[76:79], a[60:63], v[172:175]
    ds_read_b128 a[64:67], v224 offset:16384
    v_exp_f32 v164, v164
    v_mfma_f32_16x16x32_bf16 v[176:179], a[80:83], a[0:3], v[192:195]
    ds_read_b128 a[68:71], v225 offset:16384
    v_exp_f32 v165, v165
    v_mfma_f32_16x16x32_bf16 v[176:179], a[84:87], a[4:7], v[176:179]
    ds_read_b128 a[72:75], v226 offset:16384
    v_exp_f32 v166, v166
    v_mfma_f32_16x16x32_bf16 v[176:179], a[88:91], a[8:11], v[176:179]
    ds_read_b128 a[76:79], v227 offset:16384
    v_exp_f32 v167, v167
    v_mfma_f32_16x16x32_bf16 v[176:179], a[92:95], a[12:15], v[176:179]
    s_add_u32 m0, s29, 73728
    v_cvt_pk_bf16_f32 v210, v164, v165
    v_accvgpr_write_b32 a116, v210
    v_mfma_f32_16x16x32_bf16 v[180:183], a[80:83], a[16:19], v[196:199]
    s_add_u32 s39, s29, 40960
    v_cvt_pk_bf16_f32 v211, v166, v167
    v_accvgpr_write_b32 a117, v211
    v_mfma_f32_16x16x32_bf16 v[180:183], a[84:87], a[20:23], v[180:183]
    buffer_load_dwordx4 v228, s[16:19], s39 offen nt lds
    v_mfma_f32_16x16x32_bf16 v[180:183], a[88:91], a[24:27], v[180:183]
    buffer_load_dwordx4 v229, s[16:19], s39 offen offset:1024 nt lds
    v_mfma_f32_16x16x32_bf16 v[180:183], a[92:95], a[28:31], v[180:183]
    v_exp_f32 v168, v168
    v_mfma_f32_16x16x32_bf16 v[184:187], a[80:83], a[32:35], v[200:203]
    v_exp_f32 v169, v169
    v_mfma_f32_16x16x32_bf16 v[184:187], a[84:87], a[36:39], v[184:187]
    v_exp_f32 v170, v170
    v_exp_f32 v171, v171
    v_mfma_f32_16x16x32_bf16 v[184:187], a[88:91], a[40:43], v[184:187]
    v_cvt_pk_bf16_f32 v208, v168, v169
    v_accvgpr_write_b32 a120, v208
    v_cvt_pk_bf16_f32 v209, v170, v171
    v_mfma_f32_16x16x32_bf16 v[184:187], a[92:95], a[44:47], v[184:187]
    v_accvgpr_write_b32 a121, v209
    v_exp_f32 v172, v172
    v_mfma_f32_16x16x32_bf16 v[188:191], a[80:83], a[48:51], v[204:207]
    v_exp_f32 v173, v173
    v_mfma_f32_16x16x32_bf16 v[188:191], a[84:87], a[52:55], v[188:191]
    s_waitcnt lgkmcnt(0)
    v_exp_f32 v174, v174
    v_mfma_f32_16x16x32_bf16 v[188:191], a[88:91], a[56:59], v[188:191]
    v_exp_f32 v175, v175
    v_cvt_pk_bf16_f32 v210, v172, v173
    v_accvgpr_write_b32 a124, v210
    v_cvt_pk_bf16_f32 v211, v174, v175
    v_accvgpr_write_b32 a125, v211
    v_exp_f32 v176, v176
    v_exp_f32 v177, v177
    v_exp_f32 v178, v178
    v_exp_f32 v179, v179
    v_cvt_pk_bf16_f32 v208, v176, v177
    v_accvgpr_write_b32 a114, v208
    v_cvt_pk_bf16_f32 v209, v178, v179
    v_accvgpr_write_b32 a115, v209
    v_mfma_f32_16x16x32_bf16 v[188:191], a[92:95], a[60:63], v[188:191]
    ds_read_b128 a[80:83], v224 offset:20480
    v_exp_f32 v180, v180
    v_mfma_f32_16x16x32_bf16 a[192:195], a[208:211], a[112:115], a[192:195]
    ds_read_b128 a[84:87], v225 offset:20480
    v_exp_f32 v181, v181
    v_mfma_f32_16x16x32_bf16 v[160:163], a[64:67], a[0:3], v[192:195]
    ds_read_b128 a[88:91], v226 offset:20480
    v_exp_f32 v182, v182
    v_mfma_f32_16x16x32_bf16 v[160:163], a[68:71], a[4:7], v[160:163]
    ds_read_b128 a[92:95], v227 offset:20480
    v_exp_f32 v183, v183
    v_mfma_f32_16x16x32_bf16 v[160:163], a[72:75], a[8:11], v[160:163]
    v_cvt_pk_bf16_f32 v210, v180, v181
    v_accvgpr_write_b32 a118, v210
    v_cvt_pk_bf16_f32 v211, v182, v183
    v_accvgpr_write_b32 a119, v211
    v_mfma_f32_16x16x32_bf16 v[160:163], a[76:79], a[12:15], v[160:163]
    v_exp_f32 v184, v184
    v_mfma_f32_16x16x32_bf16 a[196:199], a[208:211], a[116:119], a[196:199]
    v_exp_f32 v185, v185
    v_mfma_f32_16x16x32_bf16 v[164:167], a[64:67], a[16:19], v[196:199]
    v_exp_f32 v186, v186
    v_mfma_f32_16x16x32_bf16 v[164:167], a[68:71], a[20:23], v[164:167]
    v_exp_f32 v187, v187
    v_mfma_f32_16x16x32_bf16 v[164:167], a[72:75], a[24:27], v[164:167]
    s_add_u32 m0, s29, 81920
    v_cvt_pk_bf16_f32 v208, v184, v185
    v_accvgpr_write_b32 a122, v208
    v_cvt_pk_bf16_f32 v209, v186, v187
    v_accvgpr_write_b32 a123, v209
    v_mfma_f32_16x16x32_bf16 v[164:167], a[76:79], a[28:31], v[164:167]
    s_add_u32 s39, s29, 49152
    v_exp_f32 v188, v188
    v_mfma_f32_16x16x32_bf16 a[200:203], a[208:211], a[120:123], a[200:203]
    buffer_load_dwordx4 v228, s[16:19], s39 offen nt lds
    v_mfma_f32_16x16x32_bf16 v[168:171], a[64:67], a[32:35], v[200:203]
    buffer_load_dwordx4 v229, s[16:19], s39 offen offset:1024 nt lds
    v_mfma_f32_16x16x32_bf16 v[168:171], a[68:71], a[36:39], v[168:171]
    v_exp_f32 v189, v189
    v_mfma_f32_16x16x32_bf16 v[168:171], a[72:75], a[40:43], v[168:171]
    s_waitcnt vmcnt(6)
    s_barrier
    v_exp_f32 v190, v190
    v_exp_f32 v191, v191
    v_cvt_pk_bf16_f32 v210, v188, v189
    v_accvgpr_write_b32 a126, v210
    v_cvt_pk_bf16_f32 v211, v190, v191
    v_accvgpr_write_b32 a127, v211
    v_mfma_f32_16x16x32_bf16 v[168:171], a[76:79], a[44:47], v[168:171]
    v_exp_f32 v160, v160
    v_mfma_f32_16x16x32_bf16 a[204:207], a[208:211], a[124:127], a[204:207]
    v_exp_f32 v161, v161
    v_mfma_f32_16x16x32_bf16 v[172:175], a[64:67], a[48:51], v[204:207]
    v_exp_f32 v162, v162
    v_mfma_f32_16x16x32_bf16 v[172:175], a[68:71], a[52:55], v[172:175]
    s_waitcnt lgkmcnt(0)
    v_exp_f32 v163, v163
    v_mfma_f32_16x16x32_bf16 v[172:175], a[72:75], a[56:59], v[172:175]
    v_cvt_pk_bf16_f32 v208, v160, v161
    v_accvgpr_write_b32 a128, v208
    v_mfma_f32_16x16x32_bf16 v[172:175], a[76:79], a[60:63], v[172:175]
    ds_read_b128 a[64:67], v224 offset:24576
    v_cvt_pk_bf16_f32 v209, v162, v163
    v_mfma_f32_16x16x32_bf16 v[176:179], a[80:83], a[0:3], v[192:195]
    ds_read_b128 a[68:71], v225 offset:24576
    v_accvgpr_write_b32 a129, v209
    v_mfma_f32_16x16x32_bf16 v[176:179], a[84:87], a[4:7], v[176:179]
    ds_read_b128 a[72:75], v226 offset:24576
    v_exp_f32 v164, v164
    v_mfma_f32_16x16x32_bf16 v[176:179], a[88:91], a[8:11], v[176:179]
    ds_read_b128 a[76:79], v227 offset:24576
    v_exp_f32 v165, v165
    v_mfma_f32_16x16x32_bf16 v[176:179], a[92:95], a[12:15], v[176:179]
    v_exp_f32 v166, v166
    v_mfma_f32_16x16x32_bf16 v[180:183], a[80:83], a[16:19], v[196:199]
    v_exp_f32 v167, v167
    v_mfma_f32_16x16x32_bf16 v[180:183], a[84:87], a[20:23], v[180:183]
    v_cvt_pk_bf16_f32 v210, v164, v165
    v_accvgpr_write_b32 a132, v210
    v_mfma_f32_16x16x32_bf16 v[180:183], a[88:91], a[24:27], v[180:183]
    v_cvt_pk_bf16_f32 v211, v166, v167
    v_accvgpr_write_b32 a133, v211
    v_mfma_f32_16x16x32_bf16 v[180:183], a[92:95], a[28:31], v[180:183]
    v_exp_f32 v168, v168
    v_mfma_f32_16x16x32_bf16 v[184:187], a[80:83], a[32:35], v[200:203]
    v_exp_f32 v169, v169
    v_mfma_f32_16x16x32_bf16 v[184:187], a[84:87], a[36:39], v[184:187]
    v_exp_f32 v170, v170
    v_mfma_f32_16x16x32_bf16 v[184:187], a[88:91], a[40:43], v[184:187]
    v_exp_f32 v171, v171
    v_mfma_f32_16x16x32_bf16 v[184:187], a[92:95], a[44:47], v[184:187]
    v_cvt_pk_bf16_f32 v208, v168, v169
    v_accvgpr_write_b32 a136, v208
    v_mfma_f32_16x16x32_bf16 v[188:191], a[80:83], a[48:51], v[204:207]
    v_cvt_pk_bf16_f32 v209, v170, v171
    v_accvgpr_write_b32 a137, v209
    v_mfma_f32_16x16x32_bf16 v[188:191], a[84:87], a[52:55], v[188:191]
    s_waitcnt lgkmcnt(0)
    v_exp_f32 v172, v172
    v_mfma_f32_16x16x32_bf16 v[188:191], a[88:91], a[56:59], v[188:191]
    v_exp_f32 v173, v173
    v_exp_f32 v174, v174
    v_exp_f32 v175, v175
    v_cvt_pk_bf16_f32 v210, v172, v173
    v_accvgpr_write_b32 a140, v210
    v_cvt_pk_bf16_f32 v211, v174, v175
    v_accvgpr_write_b32 a141, v211
    v_exp_f32 v176, v176
    v_exp_f32 v177, v177
    v_exp_f32 v178, v178
    v_exp_f32 v179, v179
    v_cvt_pk_bf16_f32 v208, v176, v177
    v_accvgpr_write_b32 a130, v208
    v_cvt_pk_bf16_f32 v209, v178, v179
    v_accvgpr_write_b32 a131, v209
    v_mfma_f32_16x16x32_bf16 v[188:191], a[92:95], a[60:63], v[188:191]
    ds_read_b128 a[80:83], v224 offset:28672
    v_exp_f32 v180, v180
    v_mfma_f32_16x16x32_bf16 a[192:195], a[208:211], a[128:131], a[192:195]
    ds_read_b128 a[84:87], v225 offset:28672
    v_exp_f32 v181, v181
    v_mfma_f32_16x16x32_bf16 v[160:163], a[64:67], a[0:3], v[192:195]
    ds_read_b128 a[88:91], v226 offset:28672
    v_exp_f32 v182, v182
    v_mfma_f32_16x16x32_bf16 v[160:163], a[68:71], a[4:7], v[160:163]
    ds_read_b128 a[92:95], v227 offset:28672
    v_exp_f32 v183, v183
    v_mfma_f32_16x16x32_bf16 v[160:163], a[72:75], a[8:11], v[160:163]
    v_cvt_pk_bf16_f32 v210, v180, v181
    v_accvgpr_write_b32 a134, v210
    v_cvt_pk_bf16_f32 v211, v182, v183
    v_accvgpr_write_b32 a135, v211
    v_mfma_f32_16x16x32_bf16 v[160:163], a[76:79], a[12:15], v[160:163]
    v_exp_f32 v184, v184
    v_mfma_f32_16x16x32_bf16 a[196:199], a[208:211], a[132:135], a[196:199]
    v_exp_f32 v185, v185
    v_mfma_f32_16x16x32_bf16 v[164:167], a[64:67], a[16:19], v[196:199]
    v_exp_f32 v186, v186
    v_mfma_f32_16x16x32_bf16 v[164:167], a[68:71], a[20:23], v[164:167]
    v_exp_f32 v187, v187
    v_mfma_f32_16x16x32_bf16 v[164:167], a[72:75], a[24:27], v[164:167]
    s_add_u32 m0, s29, 90112
    v_cvt_pk_bf16_f32 v208, v184, v185
    v_accvgpr_write_b32 a138, v208
    v_cvt_pk_bf16_f32 v209, v186, v187
    v_accvgpr_write_b32 a139, v209
    v_mfma_f32_16x16x32_bf16 v[164:167], a[76:79], a[28:31], v[164:167]
    s_add_u32 s39, s29, 57344
    v_exp_f32 v188, v188
    v_mfma_f32_16x16x32_bf16 a[200:203], a[208:211], a[136:139], a[200:203]
    buffer_load_dwordx4 v228, s[16:19], s39 offen nt lds
    v_mfma_f32_16x16x32_bf16 v[168:171], a[64:67], a[32:35], v[200:203]
    buffer_load_dwordx4 v229, s[16:19], s39 offen offset:1024 nt lds
    v_mfma_f32_16x16x32_bf16 v[168:171], a[68:71], a[36:39], v[168:171]
    v_exp_f32 v189, v189
    v_mfma_f32_16x16x32_bf16 v[168:171], a[72:75], a[40:43], v[168:171]
    s_waitcnt vmcnt(6)
    s_barrier
    v_exp_f32 v190, v190
    v_exp_f32 v191, v191
    v_cvt_pk_bf16_f32 v210, v188, v189
    v_accvgpr_write_b32 a142, v210
    v_cvt_pk_bf16_f32 v211, v190, v191
    v_accvgpr_write_b32 a143, v211
    v_mfma_f32_16x16x32_bf16 v[168:171], a[76:79], a[44:47], v[168:171]
    v_exp_f32 v160, v160
    v_mfma_f32_16x16x32_bf16 a[204:207], a[208:211], a[140:143], a[204:207]
    v_exp_f32 v161, v161
    v_mfma_f32_16x16x32_bf16 v[172:175], a[64:67], a[48:51], v[204:207]
    v_exp_f32 v162, v162
    v_mfma_f32_16x16x32_bf16 v[172:175], a[68:71], a[52:55], v[172:175]
    s_waitcnt lgkmcnt(0)
    v_exp_f32 v163, v163
    v_mfma_f32_16x16x32_bf16 v[172:175], a[72:75], a[56:59], v[172:175]
    v_cvt_pk_bf16_f32 v208, v160, v161
    v_accvgpr_write_b32 a144, v208
    v_mfma_f32_16x16x32_bf16 v[172:175], a[76:79], a[60:63], v[172:175]
    v_add_u32 v224, 0xffff0000, v224
    v_cvt_pk_bf16_f32 v209, v162, v163
    v_mfma_f32_16x16x32_bf16 v[176:179], a[80:83], a[0:3], v[192:195]
    ds_read_b128 a[64:67], v224 offset:0
    v_add_u32 v225, 0xffff0000, v225
    v_mfma_f32_16x16x32_bf16 v[176:179], a[84:87], a[4:7], v[176:179]
    ds_read_b128 a[68:71], v225 offset:0
    v_add_u32 v226, 0xffff0000, v226
    v_mfma_f32_16x16x32_bf16 v[176:179], a[88:91], a[8:11], v[176:179]
    ds_read_b128 a[72:75], v226 offset:0
    v_add_u32 v227, 0xffff0000, v227
    v_mfma_f32_16x16x32_bf16 v[176:179], a[92:95], a[12:15], v[176:179]
    ds_read_b128 a[76:79], v227 offset:0
    v_accvgpr_write_b32 a145, v209
    v_mfma_f32_16x16x32_bf16 v[180:183], a[80:83], a[16:19], v[196:199]
    v_exp_f32 v164, v164
    v_mfma_f32_16x16x32_bf16 v[180:183], a[84:87], a[20:23], v[180:183]
    v_exp_f32 v165, v165
    v_mfma_f32_16x16x32_bf16 v[180:183], a[88:91], a[24:27], v[180:183]
    v_exp_f32 v166, v166
    v_mfma_f32_16x16x32_bf16 v[180:183], a[92:95], a[28:31], v[180:183]
    v_exp_f32 v167, v167
    v_mfma_f32_16x16x32_bf16 v[184:187], a[80:83], a[32:35], v[200:203]
    v_cvt_pk_bf16_f32 v210, v164, v165
    v_accvgpr_write_b32 a148, v210
    v_mfma_f32_16x16x32_bf16 v[184:187], a[84:87], a[36:39], v[184:187]
    v_cvt_pk_bf16_f32 v211, v166, v167
    v_accvgpr_write_b32 a149, v211
    v_mfma_f32_16x16x32_bf16 v[184:187], a[88:91], a[40:43], v[184:187]
    v_exp_f32 v168, v168
    v_mfma_f32_16x16x32_bf16 v[184:187], a[92:95], a[44:47], v[184:187]
    v_exp_f32 v169, v169
    v_mfma_f32_16x16x32_bf16 v[188:191], a[80:83], a[48:51], v[204:207]
    v_exp_f32 v170, v170
    v_mfma_f32_16x16x32_bf16 v[188:191], a[84:87], a[52:55], v[188:191]
    s_waitcnt lgkmcnt(0)
    v_exp_f32 v171, v171
    v_mfma_f32_16x16x32_bf16 v[188:191], a[88:91], a[56:59], v[188:191]
    v_cvt_pk_bf16_f32 v208, v168, v169
    v_accvgpr_write_b32 a152, v208
    v_cvt_pk_bf16_f32 v209, v170, v171
    v_accvgpr_write_b32 a153, v209
    v_exp_f32 v172, v172
    v_exp_f32 v173, v173
    v_exp_f32 v174, v174
    v_exp_f32 v175, v175
    v_cvt_pk_bf16_f32 v210, v172, v173
    v_accvgpr_write_b32 a156, v210
    v_cvt_pk_bf16_f32 v211, v174, v175
    v_accvgpr_write_b32 a157, v211
    v_exp_f32 v176, v176
    v_exp_f32 v177, v177
    v_exp_f32 v178, v178
    v_exp_f32 v179, v179
    v_cvt_pk_bf16_f32 v208, v176, v177
    v_accvgpr_write_b32 a146, v208
    v_cvt_pk_bf16_f32 v209, v178, v179
    v_accvgpr_write_b32 a147, v209
    v_mfma_f32_16x16x32_bf16 v[188:191], a[92:95], a[60:63], v[188:191]
    ds_read_b128 a[80:83], v224 offset:4096
    v_exp_f32 v180, v180
    v_mfma_f32_16x16x32_bf16 a[192:195], a[208:211], a[144:147], a[192:195]
    ds_read_b128 a[84:87], v225 offset:4096
    v_exp_f32 v181, v181
    v_mfma_f32_16x16x32_bf16 v[160:163], a[64:67], a[0:3], v[192:195]
    ds_read_b128 a[88:91], v226 offset:4096
    v_exp_f32 v182, v182
    v_mfma_f32_16x16x32_bf16 v[160:163], a[68:71], a[4:7], v[160:163]
    ds_read_b128 a[92:95], v227 offset:4096
    v_exp_f32 v183, v183
    v_mfma_f32_16x16x32_bf16 v[160:163], a[72:75], a[8:11], v[160:163]
    v_cvt_pk_bf16_f32 v210, v180, v181
    v_accvgpr_write_b32 a150, v210
    v_cvt_pk_bf16_f32 v211, v182, v183
    v_accvgpr_write_b32 a151, v211
    v_mfma_f32_16x16x32_bf16 v[160:163], a[76:79], a[12:15], v[160:163]
    s_add_u32 m0, s29, 98304
    v_exp_f32 v184, v184
    v_mfma_f32_16x16x32_bf16 a[196:199], a[208:211], a[148:151], a[196:199]
    s_add_u32 s39, s29, 65536
    v_exp_f32 v185, v185
    v_mfma_f32_16x16x32_bf16 v[164:167], a[64:67], a[16:19], v[196:199]
    buffer_load_dwordx4 v228, s[16:19], s39 offen nt lds
    v_mfma_f32_16x16x32_bf16 v[164:167], a[68:71], a[20:23], v[164:167]
    buffer_load_dwordx4 v229, s[16:19], s39 offen offset:1024 nt lds
    v_mfma_f32_16x16x32_bf16 v[164:167], a[72:75], a[24:27], v[164:167]
    v_exp_f32 v186, v186
    v_exp_f32 v187, v187
    v_cvt_pk_bf16_f32 v208, v184, v185
    v_accvgpr_write_b32 a154, v208
    v_cvt_pk_bf16_f32 v209, v186, v187
    v_accvgpr_write_b32 a155, v209
    v_mfma_f32_16x16x32_bf16 v[164:167], a[76:79], a[28:31], v[164:167]
    v_exp_f32 v188, v188
    v_mfma_f32_16x16x32_bf16 a[200:203], a[208:211], a[152:155], a[200:203]
    v_exp_f32 v189, v189
    v_mfma_f32_16x16x32_bf16 v[168:171], a[64:67], a[32:35], v[200:203]
    v_exp_f32 v190, v190
    v_mfma_f32_16x16x32_bf16 v[168:171], a[68:71], a[36:39], v[168:171]
    v_exp_f32 v191, v191
    v_mfma_f32_16x16x32_bf16 v[168:171], a[72:75], a[40:43], v[168:171]
    s_waitcnt vmcnt(6)
    s_barrier
    v_cvt_pk_bf16_f32 v210, v188, v189
    v_accvgpr_write_b32 a158, v210
    v_cvt_pk_bf16_f32 v211, v190, v191
    v_accvgpr_write_b32 a159, v211
    v_mfma_f32_16x16x32_bf16 v[168:171], a[76:79], a[44:47], v[168:171]
    v_exp_f32 v160, v160
    v_mfma_f32_16x16x32_bf16 a[204:207], a[208:211], a[156:159], a[204:207]
    v_exp_f32 v161, v161
    v_mfma_f32_16x16x32_bf16 v[172:175], a[64:67], a[48:51], v[204:207]
    v_exp_f32 v162, v162
    v_mfma_f32_16x16x32_bf16 v[172:175], a[68:71], a[52:55], v[172:175]
    s_waitcnt lgkmcnt(0)
    v_exp_f32 v163, v163
    v_mfma_f32_16x16x32_bf16 v[172:175], a[72:75], a[56:59], v[172:175]
    v_cvt_pk_bf16_f32 v208, v160, v161
    v_accvgpr_write_b32 a160, v208
    v_mfma_f32_16x16x32_bf16 v[172:175], a[76:79], a[60:63], v[172:175]
    ds_read_b128 a[64:67], v224 offset:8192
    v_cvt_pk_bf16_f32 v209, v162, v163
    v_mfma_f32_16x16x32_bf16 v[176:179], a[80:83], a[0:3], v[192:195]
    ds_read_b128 a[68:71], v225 offset:8192
    v_accvgpr_write_b32 a161, v209
    v_mfma_f32_16x16x32_bf16 v[176:179], a[84:87], a[4:7], v[176:179]
    ds_read_b128 a[72:75], v226 offset:8192
    v_exp_f32 v164, v164
    v_mfma_f32_16x16x32_bf16 v[176:179], a[88:91], a[8:11], v[176:179]
    ds_read_b128 a[76:79], v227 offset:8192
    v_exp_f32 v165, v165
    v_mfma_f32_16x16x32_bf16 v[176:179], a[92:95], a[12:15], v[176:179]
    s_add_u32 m0, s29, 106496
    v_exp_f32 v166, v166
    v_mfma_f32_16x16x32_bf16 v[180:183], a[80:83], a[16:19], v[196:199]
    s_add_u32 s39, s29, 73728
    v_exp_f32 v167, v167
    v_mfma_f32_16x16x32_bf16 v[180:183], a[84:87], a[20:23], v[180:183]
    buffer_load_dwordx4 v228, s[16:19], s39 offen nt lds
    v_mfma_f32_16x16x32_bf16 v[180:183], a[88:91], a[24:27], v[180:183]
    buffer_load_dwordx4 v229, s[16:19], s39 offen offset:1024 nt lds
    v_mfma_f32_16x16x32_bf16 v[180:183], a[92:95], a[28:31], v[180:183]
    v_cvt_pk_bf16_f32 v210, v164, v165
    v_accvgpr_write_b32 a164, v210
    v_mfma_f32_16x16x32_bf16 v[184:187], a[80:83], a[32:35], v[200:203]
    v_cvt_pk_bf16_f32 v211, v166, v167
    v_accvgpr_write_b32 a165, v211
    v_mfma_f32_16x16x32_bf16 v[184:187], a[84:87], a[36:39], v[184:187]
    v_exp_f32 v168, v168
    v_mfma_f32_16x16x32_bf16 v[184:187], a[88:91], a[40:43], v[184:187]
    v_exp_f32 v169, v169
    v_mfma_f32_16x16x32_bf16 v[184:187], a[92:95], a[44:47], v[184:187]
    v_exp_f32 v170, v170
    v_mfma_f32_16x16x32_bf16 v[188:191], a[80:83], a[48:51], v[204:207]
    v_exp_f32 v171, v171
    v_mfma_f32_16x16x32_bf16 v[188:191], a[84:87], a[52:55], v[188:191]
    s_waitcnt lgkmcnt(0)
    v_cvt_pk_bf16_f32 v208, v168, v169
    v_accvgpr_write_b32 a168, v208
    v_mfma_f32_16x16x32_bf16 v[188:191], a[88:91], a[56:59], v[188:191]
    v_cvt_pk_bf16_f32 v209, v170, v171
    v_accvgpr_write_b32 a169, v209
    v_exp_f32 v172, v172
    v_exp_f32 v173, v173
    v_exp_f32 v174, v174
    v_exp_f32 v175, v175
    v_cvt_pk_bf16_f32 v210, v172, v173
    v_accvgpr_write_b32 a172, v210
    v_cvt_pk_bf16_f32 v211, v174, v175
    v_accvgpr_write_b32 a173, v211
    v_exp_f32 v176, v176
    v_exp_f32 v177, v177
    v_exp_f32 v178, v178
    v_exp_f32 v179, v179
    v_cvt_pk_bf16_f32 v208, v176, v177
    v_accvgpr_write_b32 a162, v208
    v_cvt_pk_bf16_f32 v209, v178, v179
    v_accvgpr_write_b32 a163, v209
    v_mfma_f32_16x16x32_bf16 v[188:191], a[92:95], a[60:63], v[188:191]
    ds_read_b128 a[80:83], v224 offset:12288
    v_exp_f32 v180, v180
    v_mfma_f32_16x16x32_bf16 a[192:195], a[208:211], a[160:163], a[192:195]
    ds_read_b128 a[84:87], v225 offset:12288
    v_exp_f32 v181, v181
    v_mfma_f32_16x16x32_bf16 v[160:163], a[64:67], a[0:3], v[192:195]
    ds_read_b128 a[88:91], v226 offset:12288
    v_exp_f32 v182, v182
    v_mfma_f32_16x16x32_bf16 v[160:163], a[68:71], a[4:7], v[160:163]
    ds_read_b128 a[92:95], v227 offset:12288
    v_exp_f32 v183, v183
    v_mfma_f32_16x16x32_bf16 v[160:163], a[72:75], a[8:11], v[160:163]
    v_cvt_pk_bf16_f32 v210, v180, v181
    v_accvgpr_write_b32 a166, v210
    v_cvt_pk_bf16_f32 v211, v182, v183
    v_accvgpr_write_b32 a167, v211
    v_mfma_f32_16x16x32_bf16 v[160:163], a[76:79], a[12:15], v[160:163]
    v_exp_f32 v184, v184
    v_mfma_f32_16x16x32_bf16 a[196:199], a[208:211], a[164:167], a[196:199]
    v_exp_f32 v185, v185
    v_mfma_f32_16x16x32_bf16 v[164:167], a[64:67], a[16:19], v[196:199]
    v_exp_f32 v186, v186
    v_mfma_f32_16x16x32_bf16 v[164:167], a[68:71], a[20:23], v[164:167]
    v_exp_f32 v187, v187
    v_mfma_f32_16x16x32_bf16 v[164:167], a[72:75], a[24:27], v[164:167]
    s_add_u32 m0, s29, 114688
    v_cvt_pk_bf16_f32 v208, v184, v185
    v_accvgpr_write_b32 a170, v208
    v_cvt_pk_bf16_f32 v209, v186, v187
    v_accvgpr_write_b32 a171, v209
    v_mfma_f32_16x16x32_bf16 v[164:167], a[76:79], a[28:31], v[164:167]
    s_add_u32 s39, s29, 81920
    v_exp_f32 v188, v188
    v_mfma_f32_16x16x32_bf16 a[200:203], a[208:211], a[168:171], a[200:203]
    buffer_load_dwordx4 v228, s[16:19], s39 offen nt lds
    v_mfma_f32_16x16x32_bf16 v[168:171], a[64:67], a[32:35], v[200:203]
    buffer_load_dwordx4 v229, s[16:19], s39 offen offset:1024 nt lds
    v_mfma_f32_16x16x32_bf16 v[168:171], a[68:71], a[36:39], v[168:171]
    v_exp_f32 v189, v189
    v_mfma_f32_16x16x32_bf16 v[168:171], a[72:75], a[40:43], v[168:171]
    s_waitcnt vmcnt(8)
    s_barrier
    v_exp_f32 v190, v190
    v_exp_f32 v191, v191
    v_cvt_pk_bf16_f32 v210, v188, v189
    v_accvgpr_write_b32 a174, v210
    v_cvt_pk_bf16_f32 v211, v190, v191
    v_accvgpr_write_b32 a175, v211
    v_mfma_f32_16x16x32_bf16 v[168:171], a[76:79], a[44:47], v[168:171]
    v_exp_f32 v160, v160
    v_mfma_f32_16x16x32_bf16 a[204:207], a[208:211], a[172:175], a[204:207]
    v_exp_f32 v161, v161
    v_mfma_f32_16x16x32_bf16 v[172:175], a[64:67], a[48:51], v[204:207]
    v_exp_f32 v162, v162
    v_mfma_f32_16x16x32_bf16 v[172:175], a[68:71], a[52:55], v[172:175]
    s_waitcnt lgkmcnt(0)
    v_exp_f32 v163, v163
    v_mfma_f32_16x16x32_bf16 v[172:175], a[72:75], a[56:59], v[172:175]
    v_cvt_pk_bf16_f32 v208, v160, v161
    v_accvgpr_write_b32 a176, v208
    v_mfma_f32_16x16x32_bf16 v[172:175], a[76:79], a[60:63], v[172:175]
    ds_read_b128 a[64:67], v224 offset:16384
    v_cvt_pk_bf16_f32 v209, v162, v163
    v_mfma_f32_16x16x32_bf16 v[176:179], a[80:83], a[0:3], v[192:195]
    ds_read_b128 a[68:71], v225 offset:16384
    v_accvgpr_write_b32 a177, v209
    v_mfma_f32_16x16x32_bf16 v[176:179], a[84:87], a[4:7], v[176:179]
    ds_read_b128 a[72:75], v226 offset:16384
    v_exp_f32 v164, v164
    v_mfma_f32_16x16x32_bf16 v[176:179], a[88:91], a[8:11], v[176:179]
    ds_read_b128 a[76:79], v227 offset:16384
    v_exp_f32 v165, v165
    v_mfma_f32_16x16x32_bf16 v[176:179], a[92:95], a[12:15], v[176:179]
    v_exp_f32 v166, v166
    v_mfma_f32_16x16x32_bf16 v[180:183], a[80:83], a[16:19], v[196:199]
    v_exp_f32 v167, v167
    v_mfma_f32_16x16x32_bf16 v[180:183], a[84:87], a[20:23], v[180:183]
    v_cvt_pk_bf16_f32 v210, v164, v165
    v_accvgpr_write_b32 a180, v210
    v_mfma_f32_16x16x32_bf16 v[180:183], a[88:91], a[24:27], v[180:183]
    v_cvt_pk_bf16_f32 v211, v166, v167
    v_accvgpr_write_b32 a181, v211
    v_mfma_f32_16x16x32_bf16 v[180:183], a[92:95], a[28:31], v[180:183]
    v_exp_f32 v168, v168
    v_mfma_f32_16x16x32_bf16 v[184:187], a[80:83], a[32:35], v[200:203]
    v_exp_f32 v169, v169
    v_mfma_f32_16x16x32_bf16 v[184:187], a[84:87], a[36:39], v[184:187]
    v_exp_f32 v170, v170
    v_mfma_f32_16x16x32_bf16 v[184:187], a[88:91], a[40:43], v[184:187]
    v_exp_f32 v171, v171
    v_mfma_f32_16x16x32_bf16 v[184:187], a[92:95], a[44:47], v[184:187]
    v_cvt_pk_bf16_f32 v208, v168, v169
    v_accvgpr_write_b32 a184, v208
    v_mfma_f32_16x16x32_bf16 v[188:191], a[80:83], a[48:51], v[204:207]
    v_cvt_pk_bf16_f32 v209, v170, v171
    v_accvgpr_write_b32 a185, v209
    v_mfma_f32_16x16x32_bf16 v[188:191], a[84:87], a[52:55], v[188:191]
    s_waitcnt lgkmcnt(0)
    v_exp_f32 v172, v172
    v_mfma_f32_16x16x32_bf16 v[188:191], a[88:91], a[56:59], v[188:191]
    v_exp_f32 v173, v173
    v_exp_f32 v174, v174
    v_exp_f32 v175, v175
    v_cvt_pk_bf16_f32 v210, v172, v173
    v_accvgpr_write_b32 a188, v210
    v_cvt_pk_bf16_f32 v211, v174, v175
    v_accvgpr_write_b32 a189, v211
    v_exp_f32 v176, v176
    v_exp_f32 v177, v177
    v_exp_f32 v178, v178
    v_exp_f32 v179, v179
    v_cvt_pk_bf16_f32 v208, v176, v177
    v_accvgpr_write_b32 a178, v208
    v_cvt_pk_bf16_f32 v209, v178, v179
    v_accvgpr_write_b32 a179, v209
    v_mfma_f32_16x16x32_bf16 v[188:191], a[92:95], a[60:63], v[188:191]
    ds_read_b128 a[80:83], v224 offset:20480
    v_exp_f32 v180, v180
    v_mfma_f32_16x16x32_bf16 a[192:195], a[208:211], a[176:179], a[192:195]
    ds_read_b128 a[84:87], v225 offset:20480
    v_exp_f32 v181, v181
    v_mfma_f32_16x16x32_bf16 v[160:163], a[64:67], a[0:3], v[192:195]
    ds_read_b128 a[88:91], v226 offset:20480
    v_exp_f32 v182, v182
    v_mfma_f32_16x16x32_bf16 v[160:163], a[68:71], a[4:7], v[160:163]
    ds_read_b128 a[92:95], v227 offset:20480
    v_exp_f32 v183, v183
    v_mfma_f32_16x16x32_bf16 v[160:163], a[72:75], a[8:11], v[160:163]
    v_cvt_pk_bf16_f32 v210, v180, v181
    v_accvgpr_write_b32 a182, v210
    v_cvt_pk_bf16_f32 v211, v182, v183
    v_accvgpr_write_b32 a183, v211
    v_mfma_f32_16x16x32_bf16 v[160:163], a[76:79], a[12:15], v[160:163]
    v_exp_f32 v184, v184
    v_mfma_f32_16x16x32_bf16 a[196:199], a[208:211], a[180:183], a[196:199]
    v_exp_f32 v185, v185
    v_mfma_f32_16x16x32_bf16 v[164:167], a[64:67], a[16:19], v[196:199]
    v_exp_f32 v186, v186
    v_mfma_f32_16x16x32_bf16 v[164:167], a[68:71], a[20:23], v[164:167]
    v_exp_f32 v187, v187
    v_mfma_f32_16x16x32_bf16 v[164:167], a[72:75], a[24:27], v[164:167]
    s_add_u32 m0, s29, 122880
    v_cvt_pk_bf16_f32 v208, v184, v185
    v_accvgpr_write_b32 a186, v208
    v_cvt_pk_bf16_f32 v209, v186, v187
    v_accvgpr_write_b32 a187, v209
    v_mfma_f32_16x16x32_bf16 v[164:167], a[76:79], a[28:31], v[164:167]
    s_add_u32 s39, s29, 90112
    v_exp_f32 v188, v188
    v_mfma_f32_16x16x32_bf16 a[200:203], a[208:211], a[184:187], a[200:203]
    buffer_load_dwordx4 v228, s[16:19], s39 offen nt lds
    v_mfma_f32_16x16x32_bf16 v[168:171], a[64:67], a[32:35], v[200:203]
    buffer_load_dwordx4 v229, s[16:19], s39 offen offset:1024 nt lds
    v_mfma_f32_16x16x32_bf16 v[168:171], a[68:71], a[36:39], v[168:171]
    v_exp_f32 v189, v189
    v_mfma_f32_16x16x32_bf16 v[168:171], a[72:75], a[40:43], v[168:171]
    s_waitcnt vmcnt(8)
    s_barrier
    v_exp_f32 v190, v190
    v_exp_f32 v191, v191
    v_cvt_pk_bf16_f32 v210, v188, v189
    v_accvgpr_write_b32 a190, v210
    v_cvt_pk_bf16_f32 v211, v190, v191
    v_accvgpr_write_b32 a191, v211
    v_mfma_f32_16x16x32_bf16 v[168:171], a[76:79], a[44:47], v[168:171]
    v_exp_f32 v160, v160
    v_mfma_f32_16x16x32_bf16 a[204:207], a[208:211], a[188:191], a[204:207]
    v_exp_f32 v161, v161
    v_mfma_f32_16x16x32_bf16 v[172:175], a[64:67], a[48:51], v[204:207]
    v_exp_f32 v162, v162
    v_mfma_f32_16x16x32_bf16 v[172:175], a[68:71], a[52:55], v[172:175]
    s_waitcnt lgkmcnt(0)
    v_exp_f32 v163, v163
    v_mfma_f32_16x16x32_bf16 v[172:175], a[72:75], a[56:59], v[172:175]
    v_cvt_pk_bf16_f32 v0, v160, v161
    v_cvt_pk_bf16_f32 v1, v162, v163
    v_mfma_f32_16x16x32_bf16 v[172:175], a[76:79], a[60:63], v[172:175]
    ds_read_b128 a[64:67], v224 offset:24576
    v_exp_f32 v164, v164
    v_mfma_f32_16x16x32_bf16 v[176:179], a[80:83], a[0:3], v[192:195]
    ds_read_b128 a[68:71], v225 offset:24576
    v_exp_f32 v165, v165
    v_mfma_f32_16x16x32_bf16 v[176:179], a[84:87], a[4:7], v[176:179]
    ds_read_b128 a[72:75], v226 offset:24576
    v_exp_f32 v166, v166
    v_mfma_f32_16x16x32_bf16 v[176:179], a[88:91], a[8:11], v[176:179]
    ds_read_b128 a[76:79], v227 offset:24576
    v_exp_f32 v167, v167
    v_mfma_f32_16x16x32_bf16 v[176:179], a[92:95], a[12:15], v[176:179]
    v_cvt_pk_bf16_f32 v4, v164, v165
    v_cvt_pk_bf16_f32 v5, v166, v167
    v_mfma_f32_16x16x32_bf16 v[180:183], a[80:83], a[16:19], v[196:199]
    v_exp_f32 v168, v168
    v_mfma_f32_16x16x32_bf16 v[180:183], a[84:87], a[20:23], v[180:183]
    v_exp_f32 v169, v169
    v_mfma_f32_16x16x32_bf16 v[180:183], a[88:91], a[24:27], v[180:183]
    v_exp_f32 v170, v170
    v_mfma_f32_16x16x32_bf16 v[180:183], a[92:95], a[28:31], v[180:183]
    v_exp_f32 v171, v171
    v_mfma_f32_16x16x32_bf16 v[184:187], a[80:83], a[32:35], v[200:203]
    v_cvt_pk_bf16_f32 v8, v168, v169
    v_cvt_pk_bf16_f32 v9, v170, v171
    v_mfma_f32_16x16x32_bf16 v[184:187], a[84:87], a[36:39], v[184:187]
    v_exp_f32 v172, v172
    v_mfma_f32_16x16x32_bf16 v[184:187], a[88:91], a[40:43], v[184:187]
    v_exp_f32 v173, v173
    v_mfma_f32_16x16x32_bf16 v[184:187], a[92:95], a[44:47], v[184:187]
    v_exp_f32 v174, v174
    v_mfma_f32_16x16x32_bf16 v[188:191], a[80:83], a[48:51], v[204:207]
    v_exp_f32 v175, v175
    v_mfma_f32_16x16x32_bf16 v[188:191], a[84:87], a[52:55], v[188:191]
    s_waitcnt lgkmcnt(0)
    v_cvt_pk_bf16_f32 v12, v172, v173
    v_cvt_pk_bf16_f32 v13, v174, v175
    v_mfma_f32_16x16x32_bf16 v[188:191], a[88:91], a[56:59], v[188:191]
    v_exp_f32 v176, v176
    v_exp_f32 v177, v177
    v_exp_f32 v178, v178
    v_exp_f32 v179, v179
    v_cvt_pk_bf16_f32 v2, v176, v177
    v_cvt_pk_bf16_f32 v3, v178, v179
    v_mfma_f32_16x16x32_bf16 v[188:191], a[92:95], a[60:63], v[188:191]
    ds_read_b128 a[80:83], v224 offset:28672
    v_exp_f32 v180, v180
    v_mfma_f32_16x16x32_bf16 a[192:195], a[208:211], v[0:3], a[192:195]
    ds_read_b128 a[84:87], v225 offset:28672
    v_exp_f32 v181, v181
    v_mfma_f32_16x16x32_bf16 v[160:163], a[64:67], a[0:3], v[192:195]
    ds_read_b128 a[88:91], v226 offset:28672
    v_exp_f32 v182, v182
    v_mfma_f32_16x16x32_bf16 v[160:163], a[68:71], a[4:7], v[160:163]
    ds_read_b128 a[92:95], v227 offset:28672
    v_exp_f32 v183, v183
    v_mfma_f32_16x16x32_bf16 v[160:163], a[72:75], a[8:11], v[160:163]
    v_cvt_pk_bf16_f32 v6, v180, v181
    v_cvt_pk_bf16_f32 v7, v182, v183
    v_mfma_f32_16x16x32_bf16 v[160:163], a[76:79], a[12:15], v[160:163]
    s_add_u32 m0, s29, 131072
    v_exp_f32 v184, v184
    v_mfma_f32_16x16x32_bf16 a[196:199], a[208:211], v[4:7], a[196:199]
    s_add_u32 s39, s29, 98304
    v_exp_f32 v185, v185
    v_mfma_f32_16x16x32_bf16 v[164:167], a[64:67], a[16:19], v[196:199]
    buffer_load_dwordx4 v228, s[16:19], s39 offen nt lds
    v_mfma_f32_16x16x32_bf16 v[164:167], a[68:71], a[20:23], v[164:167]
    buffer_load_dwordx4 v229, s[16:19], s39 offen offset:1024 nt lds
    v_mfma_f32_16x16x32_bf16 v[164:167], a[72:75], a[24:27], v[164:167]
    v_exp_f32 v186, v186
    v_exp_f32 v187, v187
    v_cvt_pk_bf16_f32 v10, v184, v185
    v_cvt_pk_bf16_f32 v11, v186, v187
    v_mfma_f32_16x16x32_bf16 v[164:167], a[76:79], a[28:31], v[164:167]
    v_exp_f32 v188, v188
    v_mfma_f32_16x16x32_bf16 a[200:203], a[208:211], v[8:11], a[200:203]
    v_exp_f32 v189, v189
    v_mfma_f32_16x16x32_bf16 v[168:171], a[64:67], a[32:35], v[200:203]
    v_exp_f32 v190, v190
    v_mfma_f32_16x16x32_bf16 v[168:171], a[68:71], a[36:39], v[168:171]
    v_exp_f32 v191, v191
    v_mfma_f32_16x16x32_bf16 v[168:171], a[72:75], a[40:43], v[168:171]
    s_waitcnt vmcnt(8)
    s_barrier
    v_cvt_pk_bf16_f32 v14, v188, v189
    v_cvt_pk_bf16_f32 v15, v190, v191
    v_mfma_f32_16x16x32_bf16 v[168:171], a[76:79], a[44:47], v[168:171]
    v_exp_f32 v160, v160
    v_mfma_f32_16x16x32_bf16 a[204:207], a[208:211], v[12:15], a[204:207]
    v_exp_f32 v161, v161
    v_mfma_f32_16x16x32_bf16 v[172:175], a[64:67], a[48:51], v[204:207]
    v_exp_f32 v162, v162
    v_mfma_f32_16x16x32_bf16 v[172:175], a[68:71], a[52:55], v[172:175]
    s_waitcnt lgkmcnt(0)
    v_exp_f32 v163, v163
    v_mfma_f32_16x16x32_bf16 v[172:175], a[72:75], a[56:59], v[172:175]
    v_cvt_pk_bf16_f32 v16, v160, v161
    v_cvt_pk_bf16_f32 v17, v162, v163
    v_mfma_f32_16x16x32_bf16 v[172:175], a[76:79], a[60:63], v[172:175]
    ds_read_b128 a[64:67], v224 offset:32768
    v_exp_f32 v164, v164
    v_mfma_f32_16x16x32_bf16 v[176:179], a[80:83], a[0:3], v[192:195]
    ds_read_b128 a[68:71], v225 offset:32768
    v_exp_f32 v165, v165
    v_mfma_f32_16x16x32_bf16 v[176:179], a[84:87], a[4:7], v[176:179]
    ds_read_b128 a[72:75], v226 offset:32768
    v_exp_f32 v166, v166
    v_mfma_f32_16x16x32_bf16 v[176:179], a[88:91], a[8:11], v[176:179]
    ds_read_b128 a[76:79], v227 offset:32768
    v_exp_f32 v167, v167
    v_mfma_f32_16x16x32_bf16 v[176:179], a[92:95], a[12:15], v[176:179]
    s_add_u32 m0, s29, 139264
    v_cvt_pk_bf16_f32 v20, v164, v165
    v_cvt_pk_bf16_f32 v21, v166, v167
    v_mfma_f32_16x16x32_bf16 v[180:183], a[80:83], a[16:19], v[196:199]
    s_add_u32 s39, s29, 106496
    v_exp_f32 v168, v168
    v_mfma_f32_16x16x32_bf16 v[180:183], a[84:87], a[20:23], v[180:183]
    buffer_load_dwordx4 v228, s[16:19], s39 offen nt lds
    v_mfma_f32_16x16x32_bf16 v[180:183], a[88:91], a[24:27], v[180:183]
    buffer_load_dwordx4 v229, s[16:19], s39 offen offset:1024 nt lds
    v_mfma_f32_16x16x32_bf16 v[180:183], a[92:95], a[28:31], v[180:183]
    v_exp_f32 v169, v169
    v_mfma_f32_16x16x32_bf16 v[184:187], a[80:83], a[32:35], v[200:203]
    v_exp_f32 v170, v170
    v_mfma_f32_16x16x32_bf16 v[184:187], a[84:87], a[36:39], v[184:187]
    v_exp_f32 v171, v171
    v_mfma_f32_16x16x32_bf16 v[184:187], a[88:91], a[40:43], v[184:187]
    v_cvt_pk_bf16_f32 v24, v168, v169
    v_cvt_pk_bf16_f32 v25, v170, v171
    v_mfma_f32_16x16x32_bf16 v[184:187], a[92:95], a[44:47], v[184:187]
    v_exp_f32 v172, v172
    v_mfma_f32_16x16x32_bf16 v[188:191], a[80:83], a[48:51], v[204:207]
    v_exp_f32 v173, v173
    v_mfma_f32_16x16x32_bf16 v[188:191], a[84:87], a[52:55], v[188:191]
    s_waitcnt lgkmcnt(0)
    v_exp_f32 v174, v174
    v_mfma_f32_16x16x32_bf16 v[188:191], a[88:91], a[56:59], v[188:191]
    v_exp_f32 v175, v175
    v_cvt_pk_bf16_f32 v28, v172, v173
    v_cvt_pk_bf16_f32 v29, v174, v175
    v_exp_f32 v176, v176
    v_exp_f32 v177, v177
    v_exp_f32 v178, v178
    v_exp_f32 v179, v179
    v_cvt_pk_bf16_f32 v18, v176, v177
    v_cvt_pk_bf16_f32 v19, v178, v179
    v_mfma_f32_16x16x32_bf16 v[188:191], a[92:95], a[60:63], v[188:191]
    ds_read_b128 a[80:83], v224 offset:36864
    v_exp_f32 v180, v180
    v_mfma_f32_16x16x32_bf16 a[192:195], a[208:211], v[16:19], a[192:195]
    ds_read_b128 a[84:87], v225 offset:36864
    v_exp_f32 v181, v181
    v_mfma_f32_16x16x32_bf16 v[160:163], a[64:67], a[0:3], v[192:195]
    ds_read_b128 a[88:91], v226 offset:36864
    v_exp_f32 v182, v182
    v_mfma_f32_16x16x32_bf16 v[160:163], a[68:71], a[4:7], v[160:163]
    ds_read_b128 a[92:95], v227 offset:36864
    v_exp_f32 v183, v183
    v_mfma_f32_16x16x32_bf16 v[160:163], a[72:75], a[8:11], v[160:163]
    v_cvt_pk_bf16_f32 v22, v180, v181
    v_cvt_pk_bf16_f32 v23, v182, v183
    v_mfma_f32_16x16x32_bf16 v[160:163], a[76:79], a[12:15], v[160:163]
    v_exp_f32 v184, v184
    v_mfma_f32_16x16x32_bf16 a[196:199], a[208:211], v[20:23], a[196:199]
    v_exp_f32 v185, v185
    v_mfma_f32_16x16x32_bf16 v[164:167], a[64:67], a[16:19], v[196:199]
    v_exp_f32 v186, v186
    v_mfma_f32_16x16x32_bf16 v[164:167], a[68:71], a[20:23], v[164:167]
    v_exp_f32 v187, v187
    v_mfma_f32_16x16x32_bf16 v[164:167], a[72:75], a[24:27], v[164:167]
    s_add_u32 m0, s29, 147456
    v_cvt_pk_bf16_f32 v26, v184, v185
    v_cvt_pk_bf16_f32 v27, v186, v187
    v_mfma_f32_16x16x32_bf16 v[164:167], a[76:79], a[28:31], v[164:167]
    s_add_u32 s39, s29, 114688
    v_exp_f32 v188, v188
    v_mfma_f32_16x16x32_bf16 a[200:203], a[208:211], v[24:27], a[200:203]
    buffer_load_dwordx4 v228, s[16:19], s39 offen nt lds
    v_mfma_f32_16x16x32_bf16 v[168:171], a[64:67], a[32:35], v[200:203]
    buffer_load_dwordx4 v229, s[16:19], s39 offen offset:1024 nt lds
    v_mfma_f32_16x16x32_bf16 v[168:171], a[68:71], a[36:39], v[168:171]
    v_exp_f32 v189, v189
    v_mfma_f32_16x16x32_bf16 v[168:171], a[72:75], a[40:43], v[168:171]
    s_waitcnt vmcnt(10)
    s_barrier
    v_exp_f32 v190, v190
    v_exp_f32 v191, v191
    v_cvt_pk_bf16_f32 v30, v188, v189
    v_cvt_pk_bf16_f32 v31, v190, v191
    v_mfma_f32_16x16x32_bf16 v[168:171], a[76:79], a[44:47], v[168:171]
    v_exp_f32 v160, v160
    v_mfma_f32_16x16x32_bf16 a[204:207], a[208:211], v[28:31], a[204:207]
    v_exp_f32 v161, v161
    v_mfma_f32_16x16x32_bf16 v[172:175], a[64:67], a[48:51], v[204:207]
    v_exp_f32 v162, v162
    v_mfma_f32_16x16x32_bf16 v[172:175], a[68:71], a[52:55], v[172:175]
    s_waitcnt lgkmcnt(0)
    v_exp_f32 v163, v163
    v_mfma_f32_16x16x32_bf16 v[172:175], a[72:75], a[56:59], v[172:175]
    v_cvt_pk_bf16_f32 v32, v160, v161
    v_cvt_pk_bf16_f32 v33, v162, v163
    v_mfma_f32_16x16x32_bf16 v[172:175], a[76:79], a[60:63], v[172:175]
    ds_read_b128 a[64:67], v224 offset:40960
    v_exp_f32 v164, v164
    v_mfma_f32_16x16x32_bf16 v[176:179], a[80:83], a[0:3], v[192:195]
    ds_read_b128 a[68:71], v225 offset:40960
    v_exp_f32 v165, v165
    v_mfma_f32_16x16x32_bf16 v[176:179], a[84:87], a[4:7], v[176:179]
    ds_read_b128 a[72:75], v226 offset:40960
    v_exp_f32 v166, v166
    v_mfma_f32_16x16x32_bf16 v[176:179], a[88:91], a[8:11], v[176:179]
    ds_read_b128 a[76:79], v227 offset:40960
    v_exp_f32 v167, v167
    v_mfma_f32_16x16x32_bf16 v[176:179], a[92:95], a[12:15], v[176:179]
    v_cvt_pk_bf16_f32 v36, v164, v165
    v_cvt_pk_bf16_f32 v37, v166, v167
    v_mfma_f32_16x16x32_bf16 v[180:183], a[80:83], a[16:19], v[196:199]
    v_exp_f32 v168, v168
    v_mfma_f32_16x16x32_bf16 v[180:183], a[84:87], a[20:23], v[180:183]
    v_exp_f32 v169, v169
    v_mfma_f32_16x16x32_bf16 v[180:183], a[88:91], a[24:27], v[180:183]
    v_exp_f32 v170, v170
    v_mfma_f32_16x16x32_bf16 v[180:183], a[92:95], a[28:31], v[180:183]
    v_exp_f32 v171, v171
    v_mfma_f32_16x16x32_bf16 v[184:187], a[80:83], a[32:35], v[200:203]
    v_cvt_pk_bf16_f32 v40, v168, v169
    v_cvt_pk_bf16_f32 v41, v170, v171
    v_mfma_f32_16x16x32_bf16 v[184:187], a[84:87], a[36:39], v[184:187]
    v_exp_f32 v172, v172
    v_mfma_f32_16x16x32_bf16 v[184:187], a[88:91], a[40:43], v[184:187]
    v_exp_f32 v173, v173
    v_mfma_f32_16x16x32_bf16 v[184:187], a[92:95], a[44:47], v[184:187]
    v_exp_f32 v174, v174
    v_mfma_f32_16x16x32_bf16 v[188:191], a[80:83], a[48:51], v[204:207]
    v_exp_f32 v175, v175
    v_mfma_f32_16x16x32_bf16 v[188:191], a[84:87], a[52:55], v[188:191]
    s_waitcnt lgkmcnt(0)
    v_cvt_pk_bf16_f32 v44, v172, v173
    v_cvt_pk_bf16_f32 v45, v174, v175
    v_mfma_f32_16x16x32_bf16 v[188:191], a[88:91], a[56:59], v[188:191]
    v_exp_f32 v176, v176
    v_exp_f32 v177, v177
    v_exp_f32 v178, v178
    v_exp_f32 v179, v179
    v_cvt_pk_bf16_f32 v34, v176, v177
    v_cvt_pk_bf16_f32 v35, v178, v179
    v_mfma_f32_16x16x32_bf16 v[188:191], a[92:95], a[60:63], v[188:191]
    ds_read_b128 a[80:83], v224 offset:45056
    v_exp_f32 v180, v180
    v_mfma_f32_16x16x32_bf16 a[192:195], a[208:211], v[32:35], a[192:195]
    ds_read_b128 a[84:87], v225 offset:45056
    v_exp_f32 v181, v181
    v_mfma_f32_16x16x32_bf16 v[160:163], a[64:67], a[0:3], v[192:195]
    ds_read_b128 a[88:91], v226 offset:45056
    v_exp_f32 v182, v182
    v_mfma_f32_16x16x32_bf16 v[160:163], a[68:71], a[4:7], v[160:163]
    ds_read_b128 a[92:95], v227 offset:45056
    v_exp_f32 v183, v183
    v_mfma_f32_16x16x32_bf16 v[160:163], a[72:75], a[8:11], v[160:163]
    v_cvt_pk_bf16_f32 v38, v180, v181
    v_cvt_pk_bf16_f32 v39, v182, v183
    v_mfma_f32_16x16x32_bf16 v[160:163], a[76:79], a[12:15], v[160:163]
    v_exp_f32 v184, v184
    v_mfma_f32_16x16x32_bf16 a[196:199], a[208:211], v[36:39], a[196:199]
    v_exp_f32 v185, v185
    v_mfma_f32_16x16x32_bf16 v[164:167], a[64:67], a[16:19], v[196:199]
    v_exp_f32 v186, v186
    v_mfma_f32_16x16x32_bf16 v[164:167], a[68:71], a[20:23], v[164:167]
    v_exp_f32 v187, v187
    v_mfma_f32_16x16x32_bf16 v[164:167], a[72:75], a[24:27], v[164:167]
    s_add_u32 m0, s29, 155648
    v_cvt_pk_bf16_f32 v42, v184, v185
    v_cvt_pk_bf16_f32 v43, v186, v187
    v_mfma_f32_16x16x32_bf16 v[164:167], a[76:79], a[28:31], v[164:167]
    s_add_u32 s39, s29, 122880
    v_exp_f32 v188, v188
    v_mfma_f32_16x16x32_bf16 a[200:203], a[208:211], v[40:43], a[200:203]
    buffer_load_dwordx4 v228, s[16:19], s39 offen nt lds
    v_mfma_f32_16x16x32_bf16 v[168:171], a[64:67], a[32:35], v[200:203]
    buffer_load_dwordx4 v229, s[16:19], s39 offen offset:1024 nt lds
    v_mfma_f32_16x16x32_bf16 v[168:171], a[68:71], a[36:39], v[168:171]
    v_exp_f32 v189, v189
    v_mfma_f32_16x16x32_bf16 v[168:171], a[72:75], a[40:43], v[168:171]
    s_waitcnt vmcnt(10)
    s_barrier
    v_exp_f32 v190, v190
    v_exp_f32 v191, v191
    v_cvt_pk_bf16_f32 v46, v188, v189
    v_cvt_pk_bf16_f32 v47, v190, v191
    v_mfma_f32_16x16x32_bf16 v[168:171], a[76:79], a[44:47], v[168:171]
    v_exp_f32 v160, v160
    v_mfma_f32_16x16x32_bf16 a[204:207], a[208:211], v[44:47], a[204:207]
    v_exp_f32 v161, v161
    v_mfma_f32_16x16x32_bf16 v[172:175], a[64:67], a[48:51], v[204:207]
    v_exp_f32 v162, v162
    v_mfma_f32_16x16x32_bf16 v[172:175], a[68:71], a[52:55], v[172:175]
    s_waitcnt lgkmcnt(0)
    v_exp_f32 v163, v163
    v_mfma_f32_16x16x32_bf16 v[172:175], a[72:75], a[56:59], v[172:175]
    v_cvt_pk_bf16_f32 v48, v160, v161
    v_cvt_pk_bf16_f32 v49, v162, v163
    v_mfma_f32_16x16x32_bf16 v[172:175], a[76:79], a[60:63], v[172:175]
    ds_read_b128 a[64:67], v224 offset:49152
    v_exp_f32 v164, v164
    v_mfma_f32_16x16x32_bf16 v[176:179], a[80:83], a[0:3], v[192:195]
    ds_read_b128 a[68:71], v225 offset:49152
    v_exp_f32 v165, v165
    v_mfma_f32_16x16x32_bf16 v[176:179], a[84:87], a[4:7], v[176:179]
    ds_read_b128 a[72:75], v226 offset:49152
    v_exp_f32 v166, v166
    v_mfma_f32_16x16x32_bf16 v[176:179], a[88:91], a[8:11], v[176:179]
    ds_read_b128 a[76:79], v227 offset:49152
    v_exp_f32 v167, v167
    v_mfma_f32_16x16x32_bf16 v[176:179], a[92:95], a[12:15], v[176:179]
    v_cvt_pk_bf16_f32 v52, v164, v165
    v_cvt_pk_bf16_f32 v53, v166, v167
    v_mfma_f32_16x16x32_bf16 v[180:183], a[80:83], a[16:19], v[196:199]
    v_exp_f32 v168, v168
    v_mfma_f32_16x16x32_bf16 v[180:183], a[84:87], a[20:23], v[180:183]
    v_exp_f32 v169, v169
    v_mfma_f32_16x16x32_bf16 v[180:183], a[88:91], a[24:27], v[180:183]
    v_exp_f32 v170, v170
    v_mfma_f32_16x16x32_bf16 v[180:183], a[92:95], a[28:31], v[180:183]
    v_exp_f32 v171, v171
    v_mfma_f32_16x16x32_bf16 v[184:187], a[80:83], a[32:35], v[200:203]
    v_cvt_pk_bf16_f32 v56, v168, v169
    v_cvt_pk_bf16_f32 v57, v170, v171
    v_mfma_f32_16x16x32_bf16 v[184:187], a[84:87], a[36:39], v[184:187]
    v_exp_f32 v172, v172
    v_mfma_f32_16x16x32_bf16 v[184:187], a[88:91], a[40:43], v[184:187]
    v_exp_f32 v173, v173
    v_mfma_f32_16x16x32_bf16 v[184:187], a[92:95], a[44:47], v[184:187]
    v_exp_f32 v174, v174
    v_mfma_f32_16x16x32_bf16 v[188:191], a[80:83], a[48:51], v[204:207]
    v_exp_f32 v175, v175
    v_mfma_f32_16x16x32_bf16 v[188:191], a[84:87], a[52:55], v[188:191]
    s_waitcnt lgkmcnt(0)
    v_cvt_pk_bf16_f32 v60, v172, v173
    v_cvt_pk_bf16_f32 v61, v174, v175
    v_mfma_f32_16x16x32_bf16 v[188:191], a[88:91], a[56:59], v[188:191]
    v_exp_f32 v176, v176
    v_exp_f32 v177, v177
    v_exp_f32 v178, v178
    v_exp_f32 v179, v179
    v_cvt_pk_bf16_f32 v50, v176, v177
    v_cvt_pk_bf16_f32 v51, v178, v179
    v_mfma_f32_16x16x32_bf16 v[188:191], a[92:95], a[60:63], v[188:191]
    ds_read_b128 a[80:83], v224 offset:53248
    v_exp_f32 v180, v180
    v_mfma_f32_16x16x32_bf16 a[192:195], a[208:211], v[48:51], a[192:195]
    ds_read_b128 a[84:87], v225 offset:53248
    v_exp_f32 v181, v181
    v_mfma_f32_16x16x32_bf16 v[160:163], a[64:67], a[0:3], v[192:195]
    ds_read_b128 a[88:91], v226 offset:53248
    v_exp_f32 v182, v182
    v_mfma_f32_16x16x32_bf16 v[160:163], a[68:71], a[4:7], v[160:163]
    ds_read_b128 a[92:95], v227 offset:53248
    v_exp_f32 v183, v183
    v_mfma_f32_16x16x32_bf16 v[160:163], a[72:75], a[8:11], v[160:163]
    v_cvt_pk_bf16_f32 v54, v180, v181
    v_cvt_pk_bf16_f32 v55, v182, v183
    v_mfma_f32_16x16x32_bf16 v[160:163], a[76:79], a[12:15], v[160:163]
    s_add_u32 m0, s29, 0
    v_exp_f32 v184, v184
    v_mfma_f32_16x16x32_bf16 a[196:199], a[208:211], v[52:55], a[196:199]
    s_add_u32 s39, s30, 0
    v_exp_f32 v185, v185
    v_mfma_f32_16x16x32_bf16 v[164:167], a[64:67], a[16:19], v[196:199]
    buffer_load_dwordx4 v230, s[20:23], s39 offen nt lds
    v_mfma_f32_16x16x32_bf16 v[164:167], a[68:71], a[20:23], v[164:167]
    buffer_load_dwordx4 v231, s[20:23], s39 offen offset:1024 nt lds
    v_mfma_f32_16x16x32_bf16 v[164:167], a[72:75], a[24:27], v[164:167]
    v_exp_f32 v186, v186
    v_exp_f32 v187, v187
    v_cvt_pk_bf16_f32 v58, v184, v185
    v_cvt_pk_bf16_f32 v59, v186, v187
    v_mfma_f32_16x16x32_bf16 v[164:167], a[76:79], a[28:31], v[164:167]
    v_exp_f32 v188, v188
    v_mfma_f32_16x16x32_bf16 a[200:203], a[208:211], v[56:59], a[200:203]
    v_exp_f32 v189, v189
    v_mfma_f32_16x16x32_bf16 v[168:171], a[64:67], a[32:35], v[200:203]
    v_exp_f32 v190, v190
    v_mfma_f32_16x16x32_bf16 v[168:171], a[68:71], a[36:39], v[168:171]
    v_exp_f32 v191, v191
    v_mfma_f32_16x16x32_bf16 v[168:171], a[72:75], a[40:43], v[168:171]
    s_waitcnt vmcnt(10)
    s_barrier
    v_cvt_pk_bf16_f32 v62, v188, v189
    v_cvt_pk_bf16_f32 v63, v190, v191
    v_mfma_f32_16x16x32_bf16 v[168:171], a[76:79], a[44:47], v[168:171]
    v_exp_f32 v160, v160
    v_mfma_f32_16x16x32_bf16 a[204:207], a[208:211], v[60:63], a[204:207]
    v_exp_f32 v161, v161
    v_mfma_f32_16x16x32_bf16 v[172:175], a[64:67], a[48:51], v[204:207]
    v_exp_f32 v162, v162
    v_mfma_f32_16x16x32_bf16 v[172:175], a[68:71], a[52:55], v[172:175]
    s_waitcnt lgkmcnt(0)
    v_exp_f32 v163, v163
    v_mfma_f32_16x16x32_bf16 v[172:175], a[72:75], a[56:59], v[172:175]
    v_cvt_pk_bf16_f32 v64, v160, v161
    v_cvt_pk_bf16_f32 v65, v162, v163
    v_mfma_f32_16x16x32_bf16 v[172:175], a[76:79], a[60:63], v[172:175]
    ds_read_b128 a[64:67], v224 offset:57344
    v_exp_f32 v164, v164
    v_mfma_f32_16x16x32_bf16 v[176:179], a[80:83], a[0:3], v[192:195]
    ds_read_b128 a[68:71], v225 offset:57344
    v_exp_f32 v165, v165
    v_mfma_f32_16x16x32_bf16 v[176:179], a[84:87], a[4:7], v[176:179]
    ds_read_b128 a[72:75], v226 offset:57344
    v_exp_f32 v166, v166
    v_mfma_f32_16x16x32_bf16 v[176:179], a[88:91], a[8:11], v[176:179]
    ds_read_b128 a[76:79], v227 offset:57344
    v_exp_f32 v167, v167
    v_mfma_f32_16x16x32_bf16 v[176:179], a[92:95], a[12:15], v[176:179]
    s_add_u32 m0, s29, 8192
    v_cvt_pk_bf16_f32 v68, v164, v165
    v_cvt_pk_bf16_f32 v69, v166, v167
    v_mfma_f32_16x16x32_bf16 v[180:183], a[80:83], a[16:19], v[196:199]
    s_add_u32 s39, s30, 16384
    v_exp_f32 v168, v168
    v_mfma_f32_16x16x32_bf16 v[180:183], a[84:87], a[20:23], v[180:183]
    buffer_load_dwordx4 v230, s[20:23], s39 offen nt lds
    v_mfma_f32_16x16x32_bf16 v[180:183], a[88:91], a[24:27], v[180:183]
    buffer_load_dwordx4 v231, s[20:23], s39 offen offset:1024 nt lds
    v_mfma_f32_16x16x32_bf16 v[180:183], a[92:95], a[28:31], v[180:183]
    v_exp_f32 v169, v169
    v_mfma_f32_16x16x32_bf16 v[184:187], a[80:83], a[32:35], v[200:203]
    v_exp_f32 v170, v170
    v_mfma_f32_16x16x32_bf16 v[184:187], a[84:87], a[36:39], v[184:187]
    v_exp_f32 v171, v171
    v_mfma_f32_16x16x32_bf16 v[184:187], a[88:91], a[40:43], v[184:187]
    v_cvt_pk_bf16_f32 v72, v168, v169
    v_cvt_pk_bf16_f32 v73, v170, v171
    v_mfma_f32_16x16x32_bf16 v[184:187], a[92:95], a[44:47], v[184:187]
    v_exp_f32 v172, v172
    v_mfma_f32_16x16x32_bf16 v[188:191], a[80:83], a[48:51], v[204:207]
    v_exp_f32 v173, v173
    v_mfma_f32_16x16x32_bf16 v[188:191], a[84:87], a[52:55], v[188:191]
    s_waitcnt lgkmcnt(0)
    v_exp_f32 v174, v174
    v_mfma_f32_16x16x32_bf16 v[188:191], a[88:91], a[56:59], v[188:191]
    v_exp_f32 v175, v175
    v_cvt_pk_bf16_f32 v76, v172, v173
    v_cvt_pk_bf16_f32 v77, v174, v175
    v_exp_f32 v176, v176
    v_exp_f32 v177, v177
    v_exp_f32 v178, v178
    v_exp_f32 v179, v179
    v_cvt_pk_bf16_f32 v66, v176, v177
    v_cvt_pk_bf16_f32 v67, v178, v179
    v_mfma_f32_16x16x32_bf16 v[188:191], a[92:95], a[60:63], v[188:191]
    ds_read_b128 a[80:83], v224 offset:61440
    v_exp_f32 v180, v180
    v_mfma_f32_16x16x32_bf16 a[192:195], a[208:211], v[64:67], a[192:195]
    ds_read_b128 a[84:87], v225 offset:61440
    v_exp_f32 v181, v181
    v_mfma_f32_16x16x32_bf16 v[160:163], a[64:67], a[0:3], v[192:195]
    ds_read_b128 a[88:91], v226 offset:61440
    v_exp_f32 v182, v182
    v_mfma_f32_16x16x32_bf16 v[160:163], a[68:71], a[4:7], v[160:163]
    ds_read_b128 a[92:95], v227 offset:61440
    v_exp_f32 v183, v183
    v_mfma_f32_16x16x32_bf16 v[160:163], a[72:75], a[8:11], v[160:163]
    v_cvt_pk_bf16_f32 v70, v180, v181
    v_cvt_pk_bf16_f32 v71, v182, v183
    v_mfma_f32_16x16x32_bf16 v[160:163], a[76:79], a[12:15], v[160:163]
    v_exp_f32 v184, v184
    v_mfma_f32_16x16x32_bf16 a[196:199], a[208:211], v[68:71], a[196:199]
    v_exp_f32 v185, v185
    v_mfma_f32_16x16x32_bf16 v[164:167], a[64:67], a[16:19], v[196:199]
    v_exp_f32 v186, v186
    v_mfma_f32_16x16x32_bf16 v[164:167], a[68:71], a[20:23], v[164:167]
    v_exp_f32 v187, v187
    v_mfma_f32_16x16x32_bf16 v[164:167], a[72:75], a[24:27], v[164:167]
    s_add_u32 m0, s29, 16384
    v_cvt_pk_bf16_f32 v74, v184, v185
    v_cvt_pk_bf16_f32 v75, v186, v187
    v_mfma_f32_16x16x32_bf16 v[164:167], a[76:79], a[28:31], v[164:167]
    s_add_u32 s39, s30, 32768
    v_exp_f32 v188, v188
    v_mfma_f32_16x16x32_bf16 a[200:203], a[208:211], v[72:75], a[200:203]
    buffer_load_dwordx4 v230, s[20:23], s39 offen nt lds
    v_mfma_f32_16x16x32_bf16 v[168:171], a[64:67], a[32:35], v[200:203]
    buffer_load_dwordx4 v231, s[20:23], s39 offen offset:1024 nt lds
    v_mfma_f32_16x16x32_bf16 v[168:171], a[68:71], a[36:39], v[168:171]
    v_exp_f32 v189, v189
    v_mfma_f32_16x16x32_bf16 v[168:171], a[72:75], a[40:43], v[168:171]
    s_waitcnt vmcnt(12)
    s_barrier
    v_exp_f32 v190, v190
    v_exp_f32 v191, v191
    v_cvt_pk_bf16_f32 v78, v188, v189
    v_cvt_pk_bf16_f32 v79, v190, v191
    v_mfma_f32_16x16x32_bf16 v[168:171], a[76:79], a[44:47], v[168:171]
    v_exp_f32 v160, v160
    v_mfma_f32_16x16x32_bf16 a[204:207], a[208:211], v[76:79], a[204:207]
    v_exp_f32 v161, v161
    v_mfma_f32_16x16x32_bf16 v[172:175], a[64:67], a[48:51], v[204:207]
    v_exp_f32 v162, v162
    v_mfma_f32_16x16x32_bf16 v[172:175], a[68:71], a[52:55], v[172:175]
    s_waitcnt lgkmcnt(0)
    v_exp_f32 v163, v163
    v_mfma_f32_16x16x32_bf16 v[172:175], a[72:75], a[56:59], v[172:175]
    v_cvt_pk_bf16_f32 v80, v160, v161
    v_cvt_pk_bf16_f32 v81, v162, v163
    v_mfma_f32_16x16x32_bf16 v[172:175], a[76:79], a[60:63], v[172:175]
    v_add_u32 v224, 0x10000, v224
    v_exp_f32 v164, v164
    v_mfma_f32_16x16x32_bf16 v[176:179], a[80:83], a[0:3], v[192:195]
    ds_read_b128 a[64:67], v224 offset:0
    v_add_u32 v225, 0x10000, v225
    v_mfma_f32_16x16x32_bf16 v[176:179], a[84:87], a[4:7], v[176:179]
    ds_read_b128 a[68:71], v225 offset:0
    v_add_u32 v226, 0x10000, v226
    v_mfma_f32_16x16x32_bf16 v[176:179], a[88:91], a[8:11], v[176:179]
    ds_read_b128 a[72:75], v226 offset:0
    v_add_u32 v227, 0x10000, v227
    v_mfma_f32_16x16x32_bf16 v[176:179], a[92:95], a[12:15], v[176:179]
    ds_read_b128 a[76:79], v227 offset:0
    v_exp_f32 v165, v165
    v_mfma_f32_16x16x32_bf16 v[180:183], a[80:83], a[16:19], v[196:199]
    v_exp_f32 v166, v166
    v_mfma_f32_16x16x32_bf16 v[180:183], a[84:87], a[20:23], v[180:183]
    v_exp_f32 v167, v167
    v_mfma_f32_16x16x32_bf16 v[180:183], a[88:91], a[24:27], v[180:183]
    v_cvt_pk_bf16_f32 v84, v164, v165
    v_cvt_pk_bf16_f32 v85, v166, v167
    v_mfma_f32_16x16x32_bf16 v[180:183], a[92:95], a[28:31], v[180:183]
    v_exp_f32 v168, v168
    v_mfma_f32_16x16x32_bf16 v[184:187], a[80:83], a[32:35], v[200:203]
    v_exp_f32 v169, v169
    v_mfma_f32_16x16x32_bf16 v[184:187], a[84:87], a[36:39], v[184:187]
    v_exp_f32 v170, v170
    v_mfma_f32_16x16x32_bf16 v[184:187], a[88:91], a[40:43], v[184:187]
    v_exp_f32 v171, v171
    v_mfma_f32_16x16x32_bf16 v[184:187], a[92:95], a[44:47], v[184:187]
    v_cvt_pk_bf16_f32 v88, v168, v169
    v_cvt_pk_bf16_f32 v89, v170, v171
    v_mfma_f32_16x16x32_bf16 v[188:191], a[80:83], a[48:51], v[204:207]
    v_exp_f32 v172, v172
    v_mfma_f32_16x16x32_bf16 v[188:191], a[84:87], a[52:55], v[188:191]
    s_waitcnt lgkmcnt(0)
    v_exp_f32 v173, v173
    v_mfma_f32_16x16x32_bf16 v[188:191], a[88:91], a[56:59], v[188:191]
    v_exp_f32 v174, v174
    v_exp_f32 v175, v175
    v_cvt_pk_bf16_f32 v92, v172, v173
    v_cvt_pk_bf16_f32 v93, v174, v175
    v_exp_f32 v176, v176
    v_exp_f32 v177, v177
    v_exp_f32 v178, v178
    v_exp_f32 v179, v179
    v_cvt_pk_bf16_f32 v82, v176, v177
    v_cvt_pk_bf16_f32 v83, v178, v179
    v_mfma_f32_16x16x32_bf16 v[188:191], a[92:95], a[60:63], v[188:191]
    ds_read_b128 a[80:83], v224 offset:4096
    v_exp_f32 v180, v180
    v_mfma_f32_16x16x32_bf16 a[192:195], a[208:211], v[80:83], a[192:195]
    ds_read_b128 a[84:87], v225 offset:4096
    v_exp_f32 v181, v181
    v_mfma_f32_16x16x32_bf16 v[160:163], a[64:67], a[0:3], v[192:195]
    ds_read_b128 a[88:91], v226 offset:4096
    v_exp_f32 v182, v182
    v_mfma_f32_16x16x32_bf16 v[160:163], a[68:71], a[4:7], v[160:163]
    ds_read_b128 a[92:95], v227 offset:4096
    v_exp_f32 v183, v183
    v_mfma_f32_16x16x32_bf16 v[160:163], a[72:75], a[8:11], v[160:163]
    v_cvt_pk_bf16_f32 v86, v180, v181
    v_cvt_pk_bf16_f32 v87, v182, v183
    v_mfma_f32_16x16x32_bf16 v[160:163], a[76:79], a[12:15], v[160:163]
    s_add_u32 m0, s29, 24576
    v_exp_f32 v184, v184
    v_mfma_f32_16x16x32_bf16 a[196:199], a[208:211], v[84:87], a[196:199]
    s_add_u32 s39, s30, 49152
    v_exp_f32 v185, v185
    v_mfma_f32_16x16x32_bf16 v[164:167], a[64:67], a[16:19], v[196:199]
    buffer_load_dwordx4 v230, s[20:23], s39 offen nt lds
    v_mfma_f32_16x16x32_bf16 v[164:167], a[68:71], a[20:23], v[164:167]
    buffer_load_dwordx4 v231, s[20:23], s39 offen offset:1024 nt lds
    v_mfma_f32_16x16x32_bf16 v[164:167], a[72:75], a[24:27], v[164:167]
    v_exp_f32 v186, v186
    v_exp_f32 v187, v187
    v_cvt_pk_bf16_f32 v90, v184, v185
    v_cvt_pk_bf16_f32 v91, v186, v187
    v_mfma_f32_16x16x32_bf16 v[164:167], a[76:79], a[28:31], v[164:167]
    v_exp_f32 v188, v188
    v_mfma_f32_16x16x32_bf16 a[200:203], a[208:211], v[88:91], a[200:203]
    v_exp_f32 v189, v189
    v_mfma_f32_16x16x32_bf16 v[168:171], a[64:67], a[32:35], v[200:203]
    v_exp_f32 v190, v190
    v_mfma_f32_16x16x32_bf16 v[168:171], a[68:71], a[36:39], v[168:171]
    v_exp_f32 v191, v191
    v_mfma_f32_16x16x32_bf16 v[168:171], a[72:75], a[40:43], v[168:171]
    s_waitcnt vmcnt(12)
    s_barrier
    v_cvt_pk_bf16_f32 v94, v188, v189
    v_cvt_pk_bf16_f32 v95, v190, v191
    v_mfma_f32_16x16x32_bf16 v[168:171], a[76:79], a[44:47], v[168:171]
    v_exp_f32 v160, v160
    v_mfma_f32_16x16x32_bf16 a[204:207], a[208:211], v[92:95], a[204:207]
    v_exp_f32 v161, v161
    v_mfma_f32_16x16x32_bf16 v[172:175], a[64:67], a[48:51], v[204:207]
    v_exp_f32 v162, v162
    v_mfma_f32_16x16x32_bf16 v[172:175], a[68:71], a[52:55], v[172:175]
    s_waitcnt lgkmcnt(0)
    v_exp_f32 v163, v163
    v_mfma_f32_16x16x32_bf16 v[172:175], a[72:75], a[56:59], v[172:175]
    v_cvt_pk_bf16_f32 v96, v160, v161
    v_cvt_pk_bf16_f32 v97, v162, v163
    v_mfma_f32_16x16x32_bf16 v[172:175], a[76:79], a[60:63], v[172:175]
    ds_read_b128 a[64:67], v224 offset:8192
    v_exp_f32 v164, v164
    v_mfma_f32_16x16x32_bf16 v[176:179], a[80:83], a[0:3], v[192:195]
    ds_read_b128 a[68:71], v225 offset:8192
    v_exp_f32 v165, v165
    v_mfma_f32_16x16x32_bf16 v[176:179], a[84:87], a[4:7], v[176:179]
    ds_read_b128 a[72:75], v226 offset:8192
    v_exp_f32 v166, v166
    v_mfma_f32_16x16x32_bf16 v[176:179], a[88:91], a[8:11], v[176:179]
    ds_read_b128 a[76:79], v227 offset:8192
    v_exp_f32 v167, v167
    v_mfma_f32_16x16x32_bf16 v[176:179], a[92:95], a[12:15], v[176:179]
    s_add_u32 m0, s29, 32768
    v_cvt_pk_bf16_f32 v100, v164, v165
    v_cvt_pk_bf16_f32 v101, v166, v167
    v_mfma_f32_16x16x32_bf16 v[180:183], a[80:83], a[16:19], v[196:199]
    s_add_u32 s39, s30, 65536
    v_exp_f32 v168, v168
    v_mfma_f32_16x16x32_bf16 v[180:183], a[84:87], a[20:23], v[180:183]
    buffer_load_dwordx4 v230, s[20:23], s39 offen nt lds
    v_mfma_f32_16x16x32_bf16 v[180:183], a[88:91], a[24:27], v[180:183]
    buffer_load_dwordx4 v231, s[20:23], s39 offen offset:1024 nt lds
    v_mfma_f32_16x16x32_bf16 v[180:183], a[92:95], a[28:31], v[180:183]
    v_exp_f32 v169, v169
    v_mfma_f32_16x16x32_bf16 v[184:187], a[80:83], a[32:35], v[200:203]
    v_exp_f32 v170, v170
    v_mfma_f32_16x16x32_bf16 v[184:187], a[84:87], a[36:39], v[184:187]
    v_exp_f32 v171, v171
    v_mfma_f32_16x16x32_bf16 v[184:187], a[88:91], a[40:43], v[184:187]
    v_cvt_pk_bf16_f32 v104, v168, v169
    v_cvt_pk_bf16_f32 v105, v170, v171
    v_mfma_f32_16x16x32_bf16 v[184:187], a[92:95], a[44:47], v[184:187]
    v_exp_f32 v172, v172
    v_mfma_f32_16x16x32_bf16 v[188:191], a[80:83], a[48:51], v[204:207]
    v_exp_f32 v173, v173
    v_mfma_f32_16x16x32_bf16 v[188:191], a[84:87], a[52:55], v[188:191]
    s_waitcnt lgkmcnt(0)
    v_exp_f32 v174, v174
    v_mfma_f32_16x16x32_bf16 v[188:191], a[88:91], a[56:59], v[188:191]
    v_exp_f32 v175, v175
    v_cvt_pk_bf16_f32 v108, v172, v173
    v_cvt_pk_bf16_f32 v109, v174, v175
    v_exp_f32 v176, v176
    v_exp_f32 v177, v177
    v_exp_f32 v178, v178
    v_exp_f32 v179, v179
    v_cvt_pk_bf16_f32 v98, v176, v177
    v_cvt_pk_bf16_f32 v99, v178, v179
    v_mfma_f32_16x16x32_bf16 v[188:191], a[92:95], a[60:63], v[188:191]
    ds_read_b128 a[80:83], v224 offset:12288
    v_exp_f32 v180, v180
    v_mfma_f32_16x16x32_bf16 a[192:195], a[208:211], v[96:99], a[192:195]
    ds_read_b128 a[84:87], v225 offset:12288
    v_exp_f32 v181, v181
    v_mfma_f32_16x16x32_bf16 v[160:163], a[64:67], a[0:3], v[192:195]
    ds_read_b128 a[88:91], v226 offset:12288
    v_exp_f32 v182, v182
    v_mfma_f32_16x16x32_bf16 v[160:163], a[68:71], a[4:7], v[160:163]
    ds_read_b128 a[92:95], v227 offset:12288
    v_exp_f32 v183, v183
    v_mfma_f32_16x16x32_bf16 v[160:163], a[72:75], a[8:11], v[160:163]
    v_cvt_pk_bf16_f32 v102, v180, v181
    v_cvt_pk_bf16_f32 v103, v182, v183
    v_mfma_f32_16x16x32_bf16 v[160:163], a[76:79], a[12:15], v[160:163]
    v_exp_f32 v184, v184
    v_mfma_f32_16x16x32_bf16 a[196:199], a[208:211], v[100:103], a[196:199]
    v_exp_f32 v185, v185
    v_mfma_f32_16x16x32_bf16 v[164:167], a[64:67], a[16:19], v[196:199]
    v_exp_f32 v186, v186
    v_mfma_f32_16x16x32_bf16 v[164:167], a[68:71], a[20:23], v[164:167]
    v_exp_f32 v187, v187
    v_mfma_f32_16x16x32_bf16 v[164:167], a[72:75], a[24:27], v[164:167]
    s_add_u32 m0, s29, 40960
    v_cvt_pk_bf16_f32 v106, v184, v185
    v_cvt_pk_bf16_f32 v107, v186, v187
    v_mfma_f32_16x16x32_bf16 v[164:167], a[76:79], a[28:31], v[164:167]
    s_add_u32 s39, s30, 81920
    v_exp_f32 v188, v188
    v_mfma_f32_16x16x32_bf16 a[200:203], a[208:211], v[104:107], a[200:203]
    buffer_load_dwordx4 v230, s[20:23], s39 offen nt lds
    v_mfma_f32_16x16x32_bf16 v[168:171], a[64:67], a[32:35], v[200:203]
    buffer_load_dwordx4 v231, s[20:23], s39 offen offset:1024 nt lds
    v_mfma_f32_16x16x32_bf16 v[168:171], a[68:71], a[36:39], v[168:171]
    v_exp_f32 v189, v189
    v_mfma_f32_16x16x32_bf16 v[168:171], a[72:75], a[40:43], v[168:171]
    s_waitcnt vmcnt(14)
    s_barrier
    v_exp_f32 v190, v190
    v_exp_f32 v191, v191
    v_cvt_pk_bf16_f32 v110, v188, v189
    v_cvt_pk_bf16_f32 v111, v190, v191
    v_mfma_f32_16x16x32_bf16 v[168:171], a[76:79], a[44:47], v[168:171]
    v_exp_f32 v160, v160
    v_mfma_f32_16x16x32_bf16 a[204:207], a[208:211], v[108:111], a[204:207]
    v_exp_f32 v161, v161
    v_mfma_f32_16x16x32_bf16 v[172:175], a[64:67], a[48:51], v[204:207]
    v_exp_f32 v162, v162
    v_mfma_f32_16x16x32_bf16 v[172:175], a[68:71], a[52:55], v[172:175]
    s_waitcnt lgkmcnt(0)
    v_exp_f32 v163, v163
    v_mfma_f32_16x16x32_bf16 v[172:175], a[72:75], a[56:59], v[172:175]
    v_cvt_pk_bf16_f32 v112, v160, v161
    v_cvt_pk_bf16_f32 v113, v162, v163
    v_mfma_f32_16x16x32_bf16 v[172:175], a[76:79], a[60:63], v[172:175]
    ds_read_b128 a[64:67], v224 offset:16384
    v_exp_f32 v164, v164
    v_mfma_f32_16x16x32_bf16 v[176:179], a[80:83], a[0:3], v[192:195]
    ds_read_b128 a[68:71], v225 offset:16384
    v_exp_f32 v165, v165
    v_mfma_f32_16x16x32_bf16 v[176:179], a[84:87], a[4:7], v[176:179]
    ds_read_b128 a[72:75], v226 offset:16384
    v_exp_f32 v166, v166
    v_mfma_f32_16x16x32_bf16 v[176:179], a[88:91], a[8:11], v[176:179]
    ds_read_b128 a[76:79], v227 offset:16384
    v_exp_f32 v167, v167
    v_mfma_f32_16x16x32_bf16 v[176:179], a[92:95], a[12:15], v[176:179]
    v_cvt_pk_bf16_f32 v116, v164, v165
    v_cvt_pk_bf16_f32 v117, v166, v167
    v_mfma_f32_16x16x32_bf16 v[180:183], a[80:83], a[16:19], v[196:199]
    v_exp_f32 v168, v168
    v_mfma_f32_16x16x32_bf16 v[180:183], a[84:87], a[20:23], v[180:183]
    v_exp_f32 v169, v169
    v_mfma_f32_16x16x32_bf16 v[180:183], a[88:91], a[24:27], v[180:183]
    v_exp_f32 v170, v170
    v_mfma_f32_16x16x32_bf16 v[180:183], a[92:95], a[28:31], v[180:183]
    v_exp_f32 v171, v171
    v_mfma_f32_16x16x32_bf16 v[184:187], a[80:83], a[32:35], v[200:203]
    v_cvt_pk_bf16_f32 v120, v168, v169
    v_cvt_pk_bf16_f32 v121, v170, v171
    v_mfma_f32_16x16x32_bf16 v[184:187], a[84:87], a[36:39], v[184:187]
    v_exp_f32 v172, v172
    v_mfma_f32_16x16x32_bf16 v[184:187], a[88:91], a[40:43], v[184:187]
    v_exp_f32 v173, v173
    v_mfma_f32_16x16x32_bf16 v[184:187], a[92:95], a[44:47], v[184:187]
    v_exp_f32 v174, v174
    v_mfma_f32_16x16x32_bf16 v[188:191], a[80:83], a[48:51], v[204:207]
    v_exp_f32 v175, v175
    v_mfma_f32_16x16x32_bf16 v[188:191], a[84:87], a[52:55], v[188:191]
    s_waitcnt lgkmcnt(0)
    v_cvt_pk_bf16_f32 v124, v172, v173
    v_cvt_pk_bf16_f32 v125, v174, v175
    v_mfma_f32_16x16x32_bf16 v[188:191], a[88:91], a[56:59], v[188:191]
    v_exp_f32 v176, v176
    v_exp_f32 v177, v177
    v_exp_f32 v178, v178
    v_exp_f32 v179, v179
    v_cvt_pk_bf16_f32 v114, v176, v177
    v_cvt_pk_bf16_f32 v115, v178, v179
    v_mfma_f32_16x16x32_bf16 v[188:191], a[92:95], a[60:63], v[188:191]
    ds_read_b128 a[80:83], v224 offset:20480
    v_exp_f32 v180, v180
    v_mfma_f32_16x16x32_bf16 a[192:195], a[208:211], v[112:115], a[192:195]
    ds_read_b128 a[84:87], v225 offset:20480
    v_exp_f32 v181, v181
    v_mfma_f32_16x16x32_bf16 v[160:163], a[64:67], a[0:3], v[192:195]
    ds_read_b128 a[88:91], v226 offset:20480
    v_exp_f32 v182, v182
    v_mfma_f32_16x16x32_bf16 v[160:163], a[68:71], a[4:7], v[160:163]
    ds_read_b128 a[92:95], v227 offset:20480
    v_exp_f32 v183, v183
    v_mfma_f32_16x16x32_bf16 v[160:163], a[72:75], a[8:11], v[160:163]
    v_cvt_pk_bf16_f32 v118, v180, v181
    v_cvt_pk_bf16_f32 v119, v182, v183
    v_mfma_f32_16x16x32_bf16 v[160:163], a[76:79], a[12:15], v[160:163]
    s_add_u32 m0, s29, 49152
    v_exp_f32 v184, v184
    v_mfma_f32_16x16x32_bf16 a[196:199], a[208:211], v[116:119], a[196:199]
    s_add_u32 s39, s30, 98304
    v_exp_f32 v185, v185
    v_mfma_f32_16x16x32_bf16 v[164:167], a[64:67], a[16:19], v[196:199]
    buffer_load_dwordx4 v230, s[20:23], s39 offen nt lds
    v_mfma_f32_16x16x32_bf16 v[164:167], a[68:71], a[20:23], v[164:167]
    buffer_load_dwordx4 v231, s[20:23], s39 offen offset:1024 nt lds
    v_mfma_f32_16x16x32_bf16 v[164:167], a[72:75], a[24:27], v[164:167]
    v_exp_f32 v186, v186
    v_exp_f32 v187, v187
    v_cvt_pk_bf16_f32 v122, v184, v185
    v_cvt_pk_bf16_f32 v123, v186, v187
    v_mfma_f32_16x16x32_bf16 v[164:167], a[76:79], a[28:31], v[164:167]
    v_exp_f32 v188, v188
    v_mfma_f32_16x16x32_bf16 a[200:203], a[208:211], v[120:123], a[200:203]
    v_exp_f32 v189, v189
    v_mfma_f32_16x16x32_bf16 v[168:171], a[64:67], a[32:35], v[200:203]
    v_exp_f32 v190, v190
    v_mfma_f32_16x16x32_bf16 v[168:171], a[68:71], a[36:39], v[168:171]
    v_exp_f32 v191, v191
    v_mfma_f32_16x16x32_bf16 v[168:171], a[72:75], a[40:43], v[168:171]
    s_waitcnt vmcnt(14)
    s_barrier
    v_cvt_pk_bf16_f32 v126, v188, v189
    v_cvt_pk_bf16_f32 v127, v190, v191
    v_mfma_f32_16x16x32_bf16 v[168:171], a[76:79], a[44:47], v[168:171]
    v_exp_f32 v160, v160
    v_mfma_f32_16x16x32_bf16 a[204:207], a[208:211], v[124:127], a[204:207]
    v_exp_f32 v161, v161
    v_mfma_f32_16x16x32_bf16 v[172:175], a[64:67], a[48:51], v[204:207]
    v_exp_f32 v162, v162
    v_mfma_f32_16x16x32_bf16 v[172:175], a[68:71], a[52:55], v[172:175]
    s_waitcnt lgkmcnt(0)
    v_exp_f32 v163, v163
    v_mfma_f32_16x16x32_bf16 v[172:175], a[72:75], a[56:59], v[172:175]
    v_cvt_pk_bf16_f32 v128, v160, v161
    v_cvt_pk_bf16_f32 v129, v162, v163
    v_mfma_f32_16x16x32_bf16 v[172:175], a[76:79], a[60:63], v[172:175]
    ds_read_b128 a[64:67], v224 offset:24576
    v_exp_f32 v164, v164
    v_mfma_f32_16x16x32_bf16 v[176:179], a[80:83], a[0:3], v[192:195]
    ds_read_b128 a[68:71], v225 offset:24576
    v_exp_f32 v165, v165
    v_mfma_f32_16x16x32_bf16 v[176:179], a[84:87], a[4:7], v[176:179]
    ds_read_b128 a[72:75], v226 offset:24576
    v_exp_f32 v166, v166
    v_mfma_f32_16x16x32_bf16 v[176:179], a[88:91], a[8:11], v[176:179]
    ds_read_b128 a[76:79], v227 offset:24576
    v_exp_f32 v167, v167
    v_mfma_f32_16x16x32_bf16 v[176:179], a[92:95], a[12:15], v[176:179]
    s_add_u32 m0, s29, 57344
    v_cvt_pk_bf16_f32 v132, v164, v165
    v_cvt_pk_bf16_f32 v133, v166, v167
    v_mfma_f32_16x16x32_bf16 v[180:183], a[80:83], a[16:19], v[196:199]
    s_add_u32 s39, s30, 114688
    v_exp_f32 v168, v168
    v_mfma_f32_16x16x32_bf16 v[180:183], a[84:87], a[20:23], v[180:183]
    buffer_load_dwordx4 v230, s[20:23], s39 offen nt lds
    v_mfma_f32_16x16x32_bf16 v[180:183], a[88:91], a[24:27], v[180:183]
    buffer_load_dwordx4 v231, s[20:23], s39 offen offset:1024 nt lds
    v_mfma_f32_16x16x32_bf16 v[180:183], a[92:95], a[28:31], v[180:183]
    v_exp_f32 v169, v169
    v_mfma_f32_16x16x32_bf16 v[184:187], a[80:83], a[32:35], v[200:203]
    v_exp_f32 v170, v170
    v_mfma_f32_16x16x32_bf16 v[184:187], a[84:87], a[36:39], v[184:187]
    v_exp_f32 v171, v171
    v_mfma_f32_16x16x32_bf16 v[184:187], a[88:91], a[40:43], v[184:187]
    v_cvt_pk_bf16_f32 v136, v168, v169
    v_cvt_pk_bf16_f32 v137, v170, v171
    v_mfma_f32_16x16x32_bf16 v[184:187], a[92:95], a[44:47], v[184:187]
    v_exp_f32 v172, v172
    v_mfma_f32_16x16x32_bf16 v[188:191], a[80:83], a[48:51], v[204:207]
    v_exp_f32 v173, v173
    v_mfma_f32_16x16x32_bf16 v[188:191], a[84:87], a[52:55], v[188:191]
    s_waitcnt lgkmcnt(0)
    v_exp_f32 v174, v174
    v_mfma_f32_16x16x32_bf16 v[188:191], a[88:91], a[56:59], v[188:191]
    v_exp_f32 v175, v175
    v_cvt_pk_bf16_f32 v140, v172, v173
    v_cvt_pk_bf16_f32 v141, v174, v175
    v_exp_f32 v176, v176
    v_exp_f32 v177, v177
    v_exp_f32 v178, v178
    v_exp_f32 v179, v179
    v_cvt_pk_bf16_f32 v130, v176, v177
    v_cvt_pk_bf16_f32 v131, v178, v179
    v_mfma_f32_16x16x32_bf16 v[188:191], a[92:95], a[60:63], v[188:191]
    ds_read_b128 a[80:83], v224 offset:28672
    v_exp_f32 v180, v180
    v_mfma_f32_16x16x32_bf16 a[192:195], a[208:211], v[128:131], a[192:195]
    ds_read_b128 a[84:87], v225 offset:28672
    v_exp_f32 v181, v181
    v_mfma_f32_16x16x32_bf16 v[160:163], a[64:67], a[0:3], v[192:195]
    ds_read_b128 a[88:91], v226 offset:28672
    v_exp_f32 v182, v182
    v_mfma_f32_16x16x32_bf16 v[160:163], a[68:71], a[4:7], v[160:163]
    ds_read_b128 a[92:95], v227 offset:28672
    v_exp_f32 v183, v183
    v_mfma_f32_16x16x32_bf16 v[160:163], a[72:75], a[8:11], v[160:163]
    v_cvt_pk_bf16_f32 v134, v180, v181
    v_cvt_pk_bf16_f32 v135, v182, v183
    v_mfma_f32_16x16x32_bf16 v[160:163], a[76:79], a[12:15], v[160:163]
    v_exp_f32 v184, v184
    v_mfma_f32_16x16x32_bf16 a[196:199], a[208:211], v[132:135], a[196:199]
    v_exp_f32 v185, v185
    v_mfma_f32_16x16x32_bf16 v[164:167], a[64:67], a[16:19], v[196:199]
    v_exp_f32 v186, v186
    v_mfma_f32_16x16x32_bf16 v[164:167], a[68:71], a[20:23], v[164:167]
    v_exp_f32 v187, v187
    v_mfma_f32_16x16x32_bf16 v[164:167], a[72:75], a[24:27], v[164:167]
    s_add_u32 m0, s29, 65536
    v_cvt_pk_bf16_f32 v138, v184, v185
    v_cvt_pk_bf16_f32 v139, v186, v187
    v_mfma_f32_16x16x32_bf16 v[164:167], a[76:79], a[28:31], v[164:167]
    s_add_u32 s39, s30, 128
    v_exp_f32 v188, v188
    v_mfma_f32_16x16x32_bf16 a[200:203], a[208:211], v[136:139], a[200:203]
    buffer_load_dwordx4 v230, s[20:23], s39 offen nt lds
    v_mfma_f32_16x16x32_bf16 v[168:171], a[64:67], a[32:35], v[200:203]
    buffer_load_dwordx4 v231, s[20:23], s39 offen offset:1024 nt lds
    v_mfma_f32_16x16x32_bf16 v[168:171], a[68:71], a[36:39], v[168:171]
    v_exp_f32 v189, v189
    v_mfma_f32_16x16x32_bf16 v[168:171], a[72:75], a[40:43], v[168:171]
    s_waitcnt vmcnt(10)
    s_barrier
    v_exp_f32 v190, v190
    v_exp_f32 v191, v191
    v_cvt_pk_bf16_f32 v142, v188, v189
    v_cvt_pk_bf16_f32 v143, v190, v191
    v_mfma_f32_16x16x32_bf16 v[168:171], a[76:79], a[44:47], v[168:171]
    v_lshrrev_b32 v239, 2, v232
    v_bfe_u32 v238, v232, 3, 2
    v_lshlrev_b32 v238, 5, v238
    v_lshl_or_b32 v239, v239, 7, v238
    v_bfe_u32 v238, v232, 1, 1
    v_lshl_or_b32 v239, v238, 4, v239
    v_and_b32 v238, 1, v232
    v_lshl_or_b32 v242, v238, 3, v239
    v_mov_b32 v224, v242
    v_xor_b32 v225, 32, v242
    v_xor_b32 v226, 64, v242
    v_xor_b32 v227, 96, v242
    v_mfma_f32_16x16x32_bf16 a[204:207], a[208:211], v[140:143], a[204:207]
    v_exp_f32 v160, v160
    v_mfma_f32_16x16x32_bf16 v[172:175], a[64:67], a[48:51], v[204:207]
    v_exp_f32 v161, v161
    v_mfma_f32_16x16x32_bf16 v[172:175], a[68:71], a[52:55], v[172:175]
    s_waitcnt lgkmcnt(0)
    v_exp_f32 v162, v162
    v_mfma_f32_16x16x32_bf16 v[172:175], a[72:75], a[56:59], v[172:175]
    v_exp_f32 v163, v163
    v_mfma_f32_16x16x32_bf16 v[172:175], a[76:79], a[60:63], v[172:175]
    ds_read_b64_tr_b16 a[64:65], v224 offset:0
    v_cvt_pk_bf16_f32 v144, v160, v161
    v_mfma_f32_16x16x32_bf16 v[176:179], a[80:83], a[0:3], v[192:195]
    ds_read_b64_tr_b16 a[68:69], v225 offset:0
    v_cvt_pk_bf16_f32 v145, v162, v163
    v_mfma_f32_16x16x32_bf16 v[176:179], a[84:87], a[4:7], v[176:179]
    ds_read_b64_tr_b16 a[72:73], v226 offset:0
    v_exp_f32 v164, v164
    v_mfma_f32_16x16x32_bf16 v[176:179], a[88:91], a[8:11], v[176:179]
    ds_read_b64_tr_b16 a[76:77], v227 offset:0
    v_exp_f32 v165, v165
    v_mfma_f32_16x16x32_bf16 v[176:179], a[92:95], a[12:15], v[176:179]
    ds_read_b64_tr_b16 a[66:67], v224 offset:2048
    v_exp_f32 v166, v166
    v_mfma_f32_16x16x32_bf16 v[180:183], a[80:83], a[16:19], v[196:199]
    ds_read_b64_tr_b16 a[70:71], v225 offset:2048
    v_exp_f32 v167, v167
    v_mfma_f32_16x16x32_bf16 v[180:183], a[84:87], a[20:23], v[180:183]
    ds_read_b64_tr_b16 a[74:75], v226 offset:2048
    v_cvt_pk_bf16_f32 v148, v164, v165
    v_mfma_f32_16x16x32_bf16 v[180:183], a[88:91], a[24:27], v[180:183]
    ds_read_b64_tr_b16 a[78:79], v227 offset:2048
    v_cvt_pk_bf16_f32 v149, v166, v167
    v_mfma_f32_16x16x32_bf16 v[180:183], a[92:95], a[28:31], v[180:183]
    v_exp_f32 v168, v168
    v_mfma_f32_16x16x32_bf16 v[184:187], a[80:83], a[32:35], v[200:203]
    v_exp_f32 v169, v169
    v_mfma_f32_16x16x32_bf16 v[184:187], a[84:87], a[36:39], v[184:187]
    v_exp_f32 v170, v170
    v_mfma_f32_16x16x32_bf16 v[184:187], a[88:91], a[40:43], v[184:187]
    v_exp_f32 v171, v171
    v_mfma_f32_16x16x32_bf16 v[184:187], a[92:95], a[44:47], v[184:187]
    v_cvt_pk_bf16_f32 v152, v168, v169
    v_cvt_pk_bf16_f32 v153, v170, v171
    v_mfma_f32_16x16x32_bf16 v[188:191], a[80:83], a[48:51], v[204:207]
    v_exp_f32 v172, v172
    v_mfma_f32_16x16x32_bf16 v[188:191], a[84:87], a[52:55], v[188:191]
    v_exp_f32 v173, v173
    v_mfma_f32_16x16x32_bf16 v[188:191], a[88:91], a[56:59], v[188:191]
    v_exp_f32 v174, v174
    v_exp_f32 v175, v175
    v_cvt_pk_bf16_f32 v156, v172, v173
    v_cvt_pk_bf16_f32 v157, v174, v175
    v_exp_f32 v176, v176
    v_exp_f32 v177, v177
    v_exp_f32 v178, v178
    v_exp_f32 v179, v179
    v_cvt_pk_bf16_f32 v146, v176, v177
    v_cvt_pk_bf16_f32 v147, v178, v179
    v_mfma_f32_16x16x32_bf16 v[188:191], a[92:95], a[60:63], v[188:191]
    s_waitcnt lgkmcnt(2)
    v_exp_f32 v180, v180
    v_mfma_f32_16x16x32_bf16 a[192:195], a[208:211], v[144:147], a[192:195]
    ds_read_b64_tr_b16 a[80:81], v224 offset:4096
    ds_read_b64_tr_b16 a[84:85], v225 offset:4096
    ds_read_b64_tr_b16 a[88:89], v226 offset:4096
    ds_read_b64_tr_b16 a[92:93], v227 offset:4096
    ds_read_b64_tr_b16 a[82:83], v224 offset:6144
    ds_read_b64_tr_b16 a[86:87], v225 offset:6144
    ds_read_b64_tr_b16 a[90:91], v226 offset:6144
    ds_read_b64_tr_b16 a[94:95], v227 offset:6144
    v_mfma_f32_16x16x32_bf16 a[0:3], a[64:67], a[96:99], 0
    v_exp_f32 v181, v181
    v_mfma_f32_16x16x32_bf16 a[16:19], a[64:67], a[100:103], 0
    v_exp_f32 v182, v182
    v_mfma_f32_16x16x32_bf16 a[32:35], a[64:67], a[104:107], 0
    v_exp_f32 v183, v183
    v_cvt_pk_bf16_f32 v150, v180, v181
    v_cvt_pk_bf16_f32 v151, v182, v183
    v_mfma_f32_16x16x32_bf16 a[48:51], a[64:67], a[108:111], 0
    ds_read_b64_tr_b16 a[64:65], v224 offset:8192
    v_mfma_f32_16x16x32_bf16 a[196:199], a[208:211], v[148:151], a[196:199]
    ds_read_b64_tr_b16 a[66:67], v224 offset:10240
    v_mfma_f32_16x16x32_bf16 a[4:7], a[68:71], a[96:99], 0
    v_exp_f32 v184, v184
    v_mfma_f32_16x16x32_bf16 a[20:23], a[68:71], a[100:103], 0
    v_exp_f32 v185, v185
    v_mfma_f32_16x16x32_bf16 a[36:39], a[68:71], a[104:107], 0
    v_exp_f32 v186, v186
    v_exp_f32 v187, v187
    v_cvt_pk_bf16_f32 v154, v184, v185
    v_cvt_pk_bf16_f32 v155, v186, v187
    v_mfma_f32_16x16x32_bf16 a[52:55], a[68:71], a[108:111], 0
    s_waitcnt lgkmcnt(10)
    v_exp_f32 v188, v188
    v_mfma_f32_16x16x32_bf16 a[200:203], a[208:211], v[152:155], a[200:203]
    ds_read_b64_tr_b16 a[68:69], v225 offset:8192
    v_mfma_f32_16x16x32_bf16 a[8:11], a[72:75], a[96:99], 0
    ds_read_b64_tr_b16 a[70:71], v225 offset:10240
    v_mfma_f32_16x16x32_bf16 a[24:27], a[72:75], a[100:103], 0
    v_exp_f32 v189, v189
    v_mfma_f32_16x16x32_bf16 a[40:43], a[72:75], a[104:107], 0
    v_exp_f32 v190, v190
    v_exp_f32 v191, v191
    v_cvt_pk_bf16_f32 v158, v188, v189
    v_cvt_pk_bf16_f32 v159, v190, v191
    v_mfma_f32_16x16x32_bf16 a[56:59], a[72:75], a[108:111], 0
    ds_read_b64_tr_b16 a[72:73], v226 offset:8192
    v_mfma_f32_16x16x32_bf16 a[204:207], a[208:211], v[156:159], a[204:207]
    ds_read_b64_tr_b16 a[74:75], v226 offset:10240
    v_mfma_f32_16x16x32_bf16 a[12:15], a[76:79], a[96:99], 0
    v_mfma_f32_16x16x32_bf16 a[28:31], a[76:79], a[100:103], 0
    v_and_b32 v240, 15, v232
    v_and_b32 v238, 7, v232
    v_mfma_f32_16x16x32_bf16 a[44:47], a[76:79], a[104:107], 0
    s_waitcnt lgkmcnt(8)
    v_lshrrev_b32 v241, 5, v232
    v_xor_b32 v241, v241, v238
    v_mfma_f32_16x16x32_bf16 a[60:63], a[76:79], a[108:111], 0
    ds_read_b64_tr_b16 a[76:77], v227 offset:8192
    v_lshlrev_b32 v241, 4, v241
    v_mfma_f32_16x16x32_bf16 a[0:3], a[80:83], a[112:115], a[0:3]
    ds_read_b64_tr_b16 a[78:79], v227 offset:10240
    v_lshl_or_b32 v241, v240, 7, v241
    v_mfma_f32_16x16x32_bf16 a[16:19], a[80:83], a[116:119], a[16:19]
    s_add_u32 m0, s29, 73728
    v_bfe_u32 v240, v232, 4, 1
    v_lshl_or_b32 v241, v240, 3, v241
    v_mfma_f32_16x16x32_bf16 a[32:35], a[80:83], a[120:123], a[32:35]
    s_add_u32 s39, s30, 16512
    v_add_u32 v246, s43, v241
    v_xor_b32 v247, 32, v246
    v_mfma_f32_16x16x32_bf16 a[48:51], a[80:83], a[124:127], a[48:51]
    ds_read_b64_tr_b16 a[80:81], v224 offset:12288
    v_xor_b32 v248, 64, v246
    v_mfma_f32_16x16x32_bf16 a[4:7], a[84:87], a[112:115], a[4:7]
    ds_read_b64_tr_b16 a[82:83], v224 offset:14336
    v_xor_b32 v249, 96, v246
    v_mfma_f32_16x16x32_bf16 a[20:23], a[84:87], a[116:119], a[20:23]
    buffer_load_dwordx4 v230, s[20:23], s39 offen nt lds
    v_mfma_f32_16x16x32_bf16 a[36:39], a[84:87], a[120:123], a[36:39]
    s_waitcnt lgkmcnt(10)
    v_lshrrev_b32 v240, 3, v232
    v_xor_b32 v241, v238, v240
    v_mfma_f32_16x16x32_bf16 a[52:55], a[84:87], a[124:127], a[52:55]
    buffer_load_dwordx4 v231, s[20:23], s39 offen offset:1024 nt lds
    v_mfma_f32_16x16x32_bf16 a[8:11], a[88:91], a[112:115], a[8:11]
    ds_read_b64_tr_b16 a[84:85], v225 offset:12288
    v_lshlrev_b32 v241, 4, v241
    v_mfma_f32_16x16x32_bf16 a[24:27], a[88:91], a[116:119], a[24:27]
    ds_read_b64_tr_b16 a[86:87], v225 offset:14336
    v_lshl_or_b32 v239, v240, 7, v241
    v_mfma_f32_16x16x32_bf16 a[40:43], a[88:91], a[120:123], a[40:43]
    v_add_u32 v239, s43, v239
    v_lshlrev_b32 v238, 4, v238
    v_mfma_f32_16x16x32_bf16 a[56:59], a[88:91], a[124:127], a[56:59]
    ds_read_b64_tr_b16 a[88:89], v226 offset:12288
    v_lshl_or_b32 v240, v240, 8, v238
    v_mfma_f32_16x16x32_bf16 a[12:15], a[92:95], a[112:115], a[12:15]
    ds_read_b64_tr_b16 a[90:91], v226 offset:14336
    v_accvgpr_read_b32 v242, a192
    v_mfma_f32_16x16x32_bf16 a[28:31], a[92:95], a[116:119], a[28:31]
    v_accvgpr_read_b32 v243, a196
    v_accvgpr_read_b32 v244, a200
    v_mfma_f32_16x16x32_bf16 a[44:47], a[92:95], a[120:123], a[44:47]
    s_waitcnt lgkmcnt(10)
    v_accvgpr_read_b32 v245, a204
    v_add_f32 v228, v242, v243
    v_mfma_f32_16x16x32_bf16 a[60:63], a[92:95], a[124:127], a[60:63]
    ds_read_b64_tr_b16 a[92:93], v227 offset:12288
    v_add_f32 v229, v244, v245
    v_mfma_f32_16x16x32_bf16 a[0:3], a[64:67], a[128:131], a[0:3]
    ds_read_b64_tr_b16 a[94:95], v227 offset:14336
    v_add_f32 v228, v228, v229
    v_mfma_f32_16x16x32_bf16 a[16:19], a[64:67], a[132:135], a[16:19]
    v_rcp_f32 v242, v242
    v_mfma_f32_16x16x32_bf16 a[32:35], a[64:67], a[136:139], a[32:35]
    v_rcp_f32 v243, v243
    v_mfma_f32_16x16x32_bf16 a[48:51], a[64:67], a[140:143], a[48:51]
    ds_read_b64_tr_b16 a[64:65], v224 offset:16384
    v_mfma_f32_16x16x32_bf16 a[4:7], a[68:71], a[128:131], a[4:7]
    ds_read_b64_tr_b16 a[66:67], v224 offset:18432
    v_mfma_f32_16x16x32_bf16 a[20:23], a[68:71], a[132:135], a[20:23]
    v_rcp_f32 v244, v244
    v_mfma_f32_16x16x32_bf16 a[36:39], a[68:71], a[136:139], a[36:39]
    s_waitcnt lgkmcnt(10)
    v_rcp_f32 v245, v245
    v_mfma_f32_16x16x32_bf16 a[52:55], a[68:71], a[140:143], a[52:55]
    ds_read_b64_tr_b16 a[68:69], v225 offset:16384
    v_mfma_f32_16x16x32_bf16 a[8:11], a[72:75], a[128:131], a[8:11]
    ds_read_b64_tr_b16 a[70:71], v225 offset:18432
    v_mfma_f32_16x16x32_bf16 a[24:27], a[72:75], a[132:135], a[24:27]
    s_add_u32 m0, s29, 81920
    v_mfma_f32_16x16x32_bf16 a[40:43], a[72:75], a[136:139], a[40:43]
    s_add_u32 s39, s30, 32896
    v_mfma_f32_16x16x32_bf16 a[56:59], a[72:75], a[140:143], a[56:59]
    ds_read_b64_tr_b16 a[72:73], v226 offset:16384
    v_mfma_f32_16x16x32_bf16 a[12:15], a[76:79], a[128:131], a[12:15]
    ds_read_b64_tr_b16 a[74:75], v226 offset:18432
    v_mfma_f32_16x16x32_bf16 a[28:31], a[76:79], a[132:135], a[28:31]
    buffer_load_dwordx4 v230, s[20:23], s39 offen nt lds
    v_mfma_f32_16x16x32_bf16 a[44:47], a[76:79], a[136:139], a[44:47]
    s_waitcnt lgkmcnt(10)
    v_mfma_f32_16x16x32_bf16 a[60:63], a[76:79], a[140:143], a[60:63]
    buffer_load_dwordx4 v231, s[20:23], s39 offen offset:1024 nt lds
    v_mfma_f32_16x16x32_bf16 a[0:3], a[80:83], a[144:147], a[0:3]
    ds_read_b64_tr_b16 a[76:77], v227 offset:16384
    v_mfma_f32_16x16x32_bf16 a[16:19], a[80:83], a[148:151], a[16:19]
    ds_read_b64_tr_b16 a[78:79], v227 offset:18432
    v_mfma_f32_16x16x32_bf16 a[32:35], a[80:83], a[152:155], a[32:35]
    v_mfma_f32_16x16x32_bf16 a[48:51], a[80:83], a[156:159], a[48:51]
    ds_read_b64_tr_b16 a[80:81], v224 offset:20480
    v_mfma_f32_16x16x32_bf16 a[4:7], a[84:87], a[144:147], a[4:7]
    ds_read_b64_tr_b16 a[82:83], v224 offset:22528
    v_mfma_f32_16x16x32_bf16 a[20:23], a[84:87], a[148:151], a[20:23]
    v_mfma_f32_16x16x32_bf16 a[36:39], a[84:87], a[152:155], a[36:39]
    s_waitcnt lgkmcnt(10)
    v_mfma_f32_16x16x32_bf16 a[52:55], a[84:87], a[156:159], a[52:55]
    ds_read_b64_tr_b16 a[84:85], v225 offset:20480
    v_mfma_f32_16x16x32_bf16 a[8:11], a[88:91], a[144:147], a[8:11]
    ds_read_b64_tr_b16 a[86:87], v225 offset:22528
    v_mfma_f32_16x16x32_bf16 a[24:27], a[88:91], a[148:151], a[24:27]
    v_mfma_f32_16x16x32_bf16 a[40:43], a[88:91], a[152:155], a[40:43]
    v_mfma_f32_16x16x32_bf16 a[56:59], a[88:91], a[156:159], a[56:59]
    ds_read_b64_tr_b16 a[88:89], v226 offset:20480
    v_mfma_f32_16x16x32_bf16 a[12:15], a[92:95], a[144:147], a[12:15]
    ds_read_b64_tr_b16 a[90:91], v226 offset:22528
    v_mfma_f32_16x16x32_bf16 a[28:31], a[92:95], a[148:151], a[28:31]
    v_mfma_f32_16x16x32_bf16 a[44:47], a[92:95], a[152:155], a[44:47]
    s_waitcnt lgkmcnt(10)
    v_mfma_f32_16x16x32_bf16 a[60:63], a[92:95], a[156:159], a[60:63]
    ds_read_b64_tr_b16 a[92:93], v227 offset:20480
    v_mfma_f32_16x16x32_bf16 a[0:3], a[64:67], a[160:163], a[0:3]
    ds_read_b64_tr_b16 a[94:95], v227 offset:22528
    v_mfma_f32_16x16x32_bf16 a[16:19], a[64:67], a[164:167], a[16:19]
    s_add_u32 m0, s29, 90112
    v_mfma_f32_16x16x32_bf16 a[32:35], a[64:67], a[168:171], a[32:35]
    s_add_u32 s39, s30, 49280
    v_mfma_f32_16x16x32_bf16 a[48:51], a[64:67], a[172:175], a[48:51]
    ds_read_b64_tr_b16 a[64:65], v224 offset:24576
    v_mfma_f32_16x16x32_bf16 a[4:7], a[68:71], a[160:163], a[4:7]
    ds_read_b64_tr_b16 a[66:67], v224 offset:26624
    v_mfma_f32_16x16x32_bf16 a[20:23], a[68:71], a[164:167], a[20:23]
    buffer_load_dwordx4 v230, s[20:23], s39 offen nt lds
    v_mfma_f32_16x16x32_bf16 a[36:39], a[68:71], a[168:171], a[36:39]
    s_waitcnt lgkmcnt(10)
    v_mfma_f32_16x16x32_bf16 a[52:55], a[68:71], a[172:175], a[52:55]
    buffer_load_dwordx4 v231, s[20:23], s39 offen offset:1024 nt lds
    v_mfma_f32_16x16x32_bf16 a[8:11], a[72:75], a[160:163], a[8:11]
    ds_read_b64_tr_b16 a[68:69], v225 offset:24576
    v_mfma_f32_16x16x32_bf16 a[24:27], a[72:75], a[164:167], a[24:27]
    ds_read_b64_tr_b16 a[70:71], v225 offset:26624
    v_mfma_f32_16x16x32_bf16 a[40:43], a[72:75], a[168:171], a[40:43]
    v_mfma_f32_16x16x32_bf16 a[56:59], a[72:75], a[172:175], a[56:59]
    ds_read_b64_tr_b16 a[72:73], v226 offset:24576
    v_mfma_f32_16x16x32_bf16 a[12:15], a[76:79], a[160:163], a[12:15]
    ds_read_b64_tr_b16 a[74:75], v226 offset:26624
    v_mfma_f32_16x16x32_bf16 a[28:31], a[76:79], a[164:167], a[28:31]
    v_mfma_f32_16x16x32_bf16 a[44:47], a[76:79], a[168:171], a[44:47]
    s_waitcnt lgkmcnt(10)
    v_mfma_f32_16x16x32_bf16 a[60:63], a[76:79], a[172:175], a[60:63]
    ds_read_b64_tr_b16 a[76:77], v227 offset:24576
    v_mfma_f32_16x16x32_bf16 a[0:3], a[80:83], a[176:179], a[0:3]
    ds_read_b64_tr_b16 a[78:79], v227 offset:26624
    v_mfma_f32_16x16x32_bf16 a[16:19], a[80:83], a[180:183], a[16:19]
    v_mfma_f32_16x16x32_bf16 a[32:35], a[80:83], a[184:187], a[32:35]
    v_mfma_f32_16x16x32_bf16 a[48:51], a[80:83], a[188:191], a[48:51]
    ds_read_b64_tr_b16 a[80:81], v224 offset:28672
    v_mfma_f32_16x16x32_bf16 a[4:7], a[84:87], a[176:179], a[4:7]
    ds_read_b64_tr_b16 a[82:83], v224 offset:30720
    v_mfma_f32_16x16x32_bf16 a[20:23], a[84:87], a[180:183], a[20:23]
    v_mfma_f32_16x16x32_bf16 a[36:39], a[84:87], a[184:187], a[36:39]
    s_waitcnt lgkmcnt(10)
    v_mfma_f32_16x16x32_bf16 a[52:55], a[84:87], a[188:191], a[52:55]
    ds_read_b64_tr_b16 a[84:85], v225 offset:28672
    v_mfma_f32_16x16x32_bf16 a[8:11], a[88:91], a[176:179], a[8:11]
    ds_read_b64_tr_b16 a[86:87], v225 offset:30720
    v_mfma_f32_16x16x32_bf16 a[24:27], a[88:91], a[180:183], a[24:27]
    s_add_u32 m0, s29, 98304
    v_mfma_f32_16x16x32_bf16 a[40:43], a[88:91], a[184:187], a[40:43]
    s_add_u32 s39, s30, 65664
    v_mfma_f32_16x16x32_bf16 a[56:59], a[88:91], a[188:191], a[56:59]
    ds_read_b64_tr_b16 a[88:89], v226 offset:28672
    v_mfma_f32_16x16x32_bf16 a[12:15], a[92:95], a[176:179], a[12:15]
    ds_read_b64_tr_b16 a[90:91], v226 offset:30720
    v_mfma_f32_16x16x32_bf16 a[28:31], a[92:95], a[180:183], a[28:31]
    buffer_load_dwordx4 v230, s[20:23], s39 offen nt lds
    v_mfma_f32_16x16x32_bf16 a[44:47], a[92:95], a[184:187], a[44:47]
    s_waitcnt lgkmcnt(10)
    v_mfma_f32_16x16x32_bf16 a[60:63], a[92:95], a[188:191], a[60:63]
    buffer_load_dwordx4 v231, s[20:23], s39 offen offset:1024 nt lds
    v_mfma_f32_16x16x32_bf16 a[0:3], a[64:67], v[0:3], a[0:3]
    ds_read_b64_tr_b16 a[92:93], v227 offset:28672
    v_mfma_f32_16x16x32_bf16 a[16:19], a[64:67], v[4:7], a[16:19]
    ds_read_b64_tr_b16 a[94:95], v227 offset:30720
    v_mfma_f32_16x16x32_bf16 a[32:35], a[64:67], v[8:11], a[32:35]
    v_mfma_f32_16x16x32_bf16 a[48:51], a[64:67], v[12:15], a[48:51]
    s_waitcnt vmcnt(14)
    s_barrier
    ds_read_b64_tr_b16 a[64:65], v224 offset:32768
    v_mfma_f32_16x16x32_bf16 a[4:7], a[68:71], v[0:3], a[4:7]
    ds_read_b64_tr_b16 a[66:67], v224 offset:34816
    v_mfma_f32_16x16x32_bf16 a[20:23], a[68:71], v[4:7], a[20:23]
    v_mfma_f32_16x16x32_bf16 a[36:39], a[68:71], v[8:11], a[36:39]
    s_waitcnt lgkmcnt(10)
    v_mfma_f32_16x16x32_bf16 a[52:55], a[68:71], v[12:15], a[52:55]
    ds_read_b64_tr_b16 a[68:69], v225 offset:32768
    v_mfma_f32_16x16x32_bf16 a[8:11], a[72:75], v[0:3], a[8:11]
    ds_read_b64_tr_b16 a[70:71], v225 offset:34816
    v_mfma_f32_16x16x32_bf16 a[24:27], a[72:75], v[4:7], a[24:27]
    v_mfma_f32_16x16x32_bf16 a[40:43], a[72:75], v[8:11], a[40:43]
    v_mfma_f32_16x16x32_bf16 a[56:59], a[72:75], v[12:15], a[56:59]
    ds_read_b64_tr_b16 a[72:73], v226 offset:32768
    v_mfma_f32_16x16x32_bf16 a[12:15], a[76:79], v[0:3], a[12:15]
    ds_read_b64_tr_b16 a[74:75], v226 offset:34816
    v_mfma_f32_16x16x32_bf16 a[28:31], a[76:79], v[4:7], a[28:31]
    v_mfma_f32_16x16x32_bf16 a[44:47], a[76:79], v[8:11], a[44:47]
    s_waitcnt lgkmcnt(10)
    v_mfma_f32_16x16x32_bf16 a[60:63], a[76:79], v[12:15], a[60:63]
    ds_read_b64_tr_b16 a[76:77], v227 offset:32768
    v_mfma_f32_16x16x32_bf16 a[0:3], a[80:83], v[16:19], a[0:3]
    ds_read_b64_tr_b16 a[78:79], v227 offset:34816
    v_mfma_f32_16x16x32_bf16 a[16:19], a[80:83], v[20:23], a[16:19]
    s_add_u32 m0, s29, 106496
    v_mfma_f32_16x16x32_bf16 a[32:35], a[80:83], v[24:27], a[32:35]
    s_add_u32 s39, s30, 82048
    v_mfma_f32_16x16x32_bf16 a[48:51], a[80:83], v[28:31], a[48:51]
    ds_read_b64_tr_b16 a[80:81], v224 offset:36864
    v_mfma_f32_16x16x32_bf16 a[4:7], a[84:87], v[16:19], a[4:7]
    ds_read_b64_tr_b16 a[82:83], v224 offset:38912
    v_mfma_f32_16x16x32_bf16 a[20:23], a[84:87], v[20:23], a[20:23]
    buffer_load_dwordx4 v230, s[20:23], s39 offen nt lds
    v_mfma_f32_16x16x32_bf16 a[36:39], a[84:87], v[24:27], a[36:39]
    s_waitcnt lgkmcnt(10)
    v_mfma_f32_16x16x32_bf16 a[52:55], a[84:87], v[28:31], a[52:55]
    buffer_load_dwordx4 v231, s[20:23], s39 offen offset:1024 nt lds
    v_mfma_f32_16x16x32_bf16 a[8:11], a[88:91], v[16:19], a[8:11]
    ds_read_b64_tr_b16 a[84:85], v225 offset:36864
    v_mfma_f32_16x16x32_bf16 a[24:27], a[88:91], v[20:23], a[24:27]
    ds_read_b64_tr_b16 a[86:87], v225 offset:38912
    v_mfma_f32_16x16x32_bf16 a[40:43], a[88:91], v[24:27], a[40:43]
    v_mfma_f32_16x16x32_bf16 a[56:59], a[88:91], v[28:31], a[56:59]
    ds_read_b64_tr_b16 a[88:89], v226 offset:36864
    v_mfma_f32_16x16x32_bf16 a[12:15], a[92:95], v[16:19], a[12:15]
    ds_read_b64_tr_b16 a[90:91], v226 offset:38912
    v_mfma_f32_16x16x32_bf16 a[28:31], a[92:95], v[20:23], a[28:31]
    v_mfma_f32_16x16x32_bf16 a[44:47], a[92:95], v[24:27], a[44:47]
    s_waitcnt lgkmcnt(10)
    v_mfma_f32_16x16x32_bf16 a[60:63], a[92:95], v[28:31], a[60:63]
    ds_read_b64_tr_b16 a[92:93], v227 offset:36864
    v_mfma_f32_16x16x32_bf16 a[0:3], a[64:67], v[32:35], a[0:3]
    ds_read_b64_tr_b16 a[94:95], v227 offset:38912
    v_mfma_f32_16x16x32_bf16 a[16:19], a[64:67], v[36:39], a[16:19]
    v_mfma_f32_16x16x32_bf16 a[32:35], a[64:67], v[40:43], a[32:35]
    v_mfma_f32_16x16x32_bf16 a[48:51], a[64:67], v[44:47], a[48:51]
    ds_read_b64_tr_b16 a[64:65], v224 offset:40960
    v_mfma_f32_16x16x32_bf16 a[4:7], a[68:71], v[32:35], a[4:7]
    ds_read_b64_tr_b16 a[66:67], v224 offset:43008
    v_mfma_f32_16x16x32_bf16 a[20:23], a[68:71], v[36:39], a[20:23]
    v_mfma_f32_16x16x32_bf16 a[36:39], a[68:71], v[40:43], a[36:39]
    s_waitcnt lgkmcnt(10)
    v_mfma_f32_16x16x32_bf16 a[52:55], a[68:71], v[44:47], a[52:55]
    ds_read_b64_tr_b16 a[68:69], v225 offset:40960
    v_mfma_f32_16x16x32_bf16 a[8:11], a[72:75], v[32:35], a[8:11]
    ds_read_b64_tr_b16 a[70:71], v225 offset:43008
    v_mfma_f32_16x16x32_bf16 a[24:27], a[72:75], v[36:39], a[24:27]
    s_add_u32 m0, s29, 114688
    v_mfma_f32_16x16x32_bf16 a[40:43], a[72:75], v[40:43], a[40:43]
    s_add_u32 s39, s30, 98432
    v_mfma_f32_16x16x32_bf16 a[56:59], a[72:75], v[44:47], a[56:59]
    ds_read_b64_tr_b16 a[72:73], v226 offset:40960
    v_mfma_f32_16x16x32_bf16 a[12:15], a[76:79], v[32:35], a[12:15]
    ds_read_b64_tr_b16 a[74:75], v226 offset:43008
    v_mfma_f32_16x16x32_bf16 a[28:31], a[76:79], v[36:39], a[28:31]
    buffer_load_dwordx4 v230, s[20:23], s39 offen nt lds
    v_mfma_f32_16x16x32_bf16 a[44:47], a[76:79], v[40:43], a[44:47]
    s_waitcnt lgkmcnt(10)
    v_mfma_f32_16x16x32_bf16 a[60:63], a[76:79], v[44:47], a[60:63]
    buffer_load_dwordx4 v231, s[20:23], s39 offen offset:1024 nt lds
    v_mfma_f32_16x16x32_bf16 a[0:3], a[80:83], v[48:51], a[0:3]
    ds_read_b64_tr_b16 a[76:77], v227 offset:40960
    v_mfma_f32_16x16x32_bf16 a[16:19], a[80:83], v[52:55], a[16:19]
    ds_read_b64_tr_b16 a[78:79], v227 offset:43008
    v_mfma_f32_16x16x32_bf16 a[32:35], a[80:83], v[56:59], a[32:35]
    v_mfma_f32_16x16x32_bf16 a[48:51], a[80:83], v[60:63], a[48:51]
    ds_read_b64_tr_b16 a[80:81], v224 offset:45056
    v_mfma_f32_16x16x32_bf16 a[4:7], a[84:87], v[48:51], a[4:7]
    ds_read_b64_tr_b16 a[82:83], v224 offset:47104
    v_mfma_f32_16x16x32_bf16 a[20:23], a[84:87], v[52:55], a[20:23]
    v_mfma_f32_16x16x32_bf16 a[36:39], a[84:87], v[56:59], a[36:39]
    s_waitcnt lgkmcnt(10)
    v_mfma_f32_16x16x32_bf16 a[52:55], a[84:87], v[60:63], a[52:55]
    ds_read_b64_tr_b16 a[84:85], v225 offset:45056
    v_mfma_f32_16x16x32_bf16 a[8:11], a[88:91], v[48:51], a[8:11]
    ds_read_b64_tr_b16 a[86:87], v225 offset:47104
    v_mfma_f32_16x16x32_bf16 a[24:27], a[88:91], v[52:55], a[24:27]
    v_mfma_f32_16x16x32_bf16 a[40:43], a[88:91], v[56:59], a[40:43]
    v_mfma_f32_16x16x32_bf16 a[56:59], a[88:91], v[60:63], a[56:59]
    ds_read_b64_tr_b16 a[88:89], v226 offset:45056
    v_mfma_f32_16x16x32_bf16 a[12:15], a[92:95], v[48:51], a[12:15]
    ds_read_b64_tr_b16 a[90:91], v226 offset:47104
    v_mfma_f32_16x16x32_bf16 a[28:31], a[92:95], v[52:55], a[28:31]
    v_mfma_f32_16x16x32_bf16 a[44:47], a[92:95], v[56:59], a[44:47]
    s_waitcnt lgkmcnt(10)
    v_mfma_f32_16x16x32_bf16 a[60:63], a[92:95], v[60:63], a[60:63]
    ds_read_b64_tr_b16 a[92:93], v227 offset:45056
    v_mfma_f32_16x16x32_bf16 a[0:3], a[64:67], v[64:67], a[0:3]
    ds_read_b64_tr_b16 a[94:95], v227 offset:47104
    v_mfma_f32_16x16x32_bf16 a[16:19], a[64:67], v[68:71], a[16:19]
    s_add_u32 m0, s29, 122880
    v_mfma_f32_16x16x32_bf16 a[32:35], a[64:67], v[72:75], a[32:35]
    s_add_u32 s39, s30, 114816
    v_mfma_f32_16x16x32_bf16 a[48:51], a[64:67], v[76:79], a[48:51]
    s_waitcnt vmcnt(14)
    s_barrier
    ds_read_b64_tr_b16 a[64:65], v224 offset:49152
    v_mfma_f32_16x16x32_bf16 a[4:7], a[68:71], v[64:67], a[4:7]
    ds_read_b64_tr_b16 a[66:67], v224 offset:51200
    v_mfma_f32_16x16x32_bf16 a[20:23], a[68:71], v[68:71], a[20:23]
    buffer_load_dwordx4 v230, s[20:23], s39 offen nt lds
    v_mfma_f32_16x16x32_bf16 a[36:39], a[68:71], v[72:75], a[36:39]
    s_waitcnt lgkmcnt(10)
    v_mfma_f32_16x16x32_bf16 a[52:55], a[68:71], v[76:79], a[52:55]
    buffer_load_dwordx4 v231, s[20:23], s39 offen offset:1024 nt lds
    v_mfma_f32_16x16x32_bf16 a[8:11], a[72:75], v[64:67], a[8:11]
    ds_read_b64_tr_b16 a[68:69], v225 offset:49152
    v_mfma_f32_16x16x32_bf16 a[24:27], a[72:75], v[68:71], a[24:27]
    ds_read_b64_tr_b16 a[70:71], v225 offset:51200
    v_mfma_f32_16x16x32_bf16 a[40:43], a[72:75], v[72:75], a[40:43]
    v_mfma_f32_16x16x32_bf16 a[56:59], a[72:75], v[76:79], a[56:59]
    ds_read_b64_tr_b16 a[72:73], v226 offset:49152
    v_mfma_f32_16x16x32_bf16 a[12:15], a[76:79], v[64:67], a[12:15]
    ds_read_b64_tr_b16 a[74:75], v226 offset:51200
    v_mfma_f32_16x16x32_bf16 a[28:31], a[76:79], v[68:71], a[28:31]
    v_mfma_f32_16x16x32_bf16 a[44:47], a[76:79], v[72:75], a[44:47]
    s_waitcnt lgkmcnt(10)
    v_mfma_f32_16x16x32_bf16 a[60:63], a[76:79], v[76:79], a[60:63]
    ds_read_b64_tr_b16 a[76:77], v227 offset:49152
    v_mfma_f32_16x16x32_bf16 a[0:3], a[80:83], v[80:83], a[0:3]
    ds_read_b64_tr_b16 a[78:79], v227 offset:51200
    v_mfma_f32_16x16x32_bf16 a[16:19], a[80:83], v[84:87], a[16:19]
    v_mfma_f32_16x16x32_bf16 a[32:35], a[80:83], v[88:91], a[32:35]
    v_mfma_f32_16x16x32_bf16 a[48:51], a[80:83], v[92:95], a[48:51]
    ds_read_b64_tr_b16 a[80:81], v224 offset:53248
    v_mfma_f32_16x16x32_bf16 a[4:7], a[84:87], v[80:83], a[4:7]
    ds_read_b64_tr_b16 a[82:83], v224 offset:55296
    v_mfma_f32_16x16x32_bf16 a[20:23], a[84:87], v[84:87], a[20:23]
    v_mfma_f32_16x16x32_bf16 a[36:39], a[84:87], v[88:91], a[36:39]
    s_waitcnt lgkmcnt(10)
    v_mfma_f32_16x16x32_bf16 a[52:55], a[84:87], v[92:95], a[52:55]
    ds_read_b64_tr_b16 a[84:85], v225 offset:53248
    v_mfma_f32_16x16x32_bf16 a[8:11], a[88:91], v[80:83], a[8:11]
    ds_read_b64_tr_b16 a[86:87], v225 offset:55296
    v_mfma_f32_16x16x32_bf16 a[24:27], a[88:91], v[84:87], a[24:27]
    v_mfma_f32_16x16x32_bf16 a[40:43], a[88:91], v[88:91], a[40:43]
    v_mfma_f32_16x16x32_bf16 a[56:59], a[88:91], v[92:95], a[56:59]
    ds_read_b64_tr_b16 a[88:89], v226 offset:53248
    v_mfma_f32_16x16x32_bf16 a[12:15], a[92:95], v[80:83], a[12:15]
    ds_read_b64_tr_b16 a[90:91], v226 offset:55296
    v_mfma_f32_16x16x32_bf16 a[28:31], a[92:95], v[84:87], a[28:31]
    v_mfma_f32_16x16x32_bf16 a[44:47], a[92:95], v[88:91], a[44:47]
    s_waitcnt lgkmcnt(10)
    v_mfma_f32_16x16x32_bf16 a[60:63], a[92:95], v[92:95], a[60:63]
    ds_read_b64_tr_b16 a[92:93], v227 offset:53248
    v_mfma_f32_16x16x32_bf16 a[0:3], a[64:67], v[96:99], a[0:3]
    ds_read_b64_tr_b16 a[94:95], v227 offset:55296
    v_mfma_f32_16x16x32_bf16 a[16:19], a[64:67], v[100:103], a[16:19]
    v_mfma_f32_16x16x32_bf16 a[32:35], a[64:67], v[104:107], a[32:35]
    v_mfma_f32_16x16x32_bf16 a[48:51], a[64:67], v[108:111], a[48:51]
    ds_read_b64_tr_b16 a[64:65], v224 offset:57344
    v_mfma_f32_16x16x32_bf16 a[4:7], a[68:71], v[96:99], a[4:7]
    ds_read_b64_tr_b16 a[66:67], v224 offset:59392
    v_mfma_f32_16x16x32_bf16 a[20:23], a[68:71], v[100:103], a[20:23]
    v_mfma_f32_16x16x32_bf16 a[36:39], a[68:71], v[104:107], a[36:39]
    s_waitcnt lgkmcnt(10)
    v_mfma_f32_16x16x32_bf16 a[52:55], a[68:71], v[108:111], a[52:55]
    ds_read_b64_tr_b16 a[68:69], v225 offset:57344
    v_mfma_f32_16x16x32_bf16 a[8:11], a[72:75], v[96:99], a[8:11]
    ds_read_b64_tr_b16 a[70:71], v225 offset:59392
    v_mfma_f32_16x16x32_bf16 a[24:27], a[72:75], v[100:103], a[24:27]
    v_mfma_f32_16x16x32_bf16 a[40:43], a[72:75], v[104:107], a[40:43]
    v_mfma_f32_16x16x32_bf16 a[56:59], a[72:75], v[108:111], a[56:59]
    ds_read_b64_tr_b16 a[72:73], v226 offset:57344
    v_mfma_f32_16x16x32_bf16 a[12:15], a[76:79], v[96:99], a[12:15]
    ds_read_b64_tr_b16 a[74:75], v226 offset:59392
    v_mfma_f32_16x16x32_bf16 a[28:31], a[76:79], v[100:103], a[28:31]
    v_mfma_f32_16x16x32_bf16 a[44:47], a[76:79], v[104:107], a[44:47]
    s_waitcnt lgkmcnt(10)
    v_mfma_f32_16x16x32_bf16 a[60:63], a[76:79], v[108:111], a[60:63]
    ds_read_b64_tr_b16 a[76:77], v227 offset:57344
    v_mfma_f32_16x16x32_bf16 a[0:3], a[80:83], v[112:115], a[0:3]
    ds_read_b64_tr_b16 a[78:79], v227 offset:59392
    v_mfma_f32_16x16x32_bf16 a[16:19], a[80:83], v[116:119], a[16:19]
    v_mfma_f32_16x16x32_bf16 a[32:35], a[80:83], v[120:123], a[32:35]
    v_mfma_f32_16x16x32_bf16 a[48:51], a[80:83], v[124:127], a[48:51]
    ds_read_b64_tr_b16 a[80:81], v224 offset:61440
    v_mfma_f32_16x16x32_bf16 a[4:7], a[84:87], v[112:115], a[4:7]
    ds_read_b64_tr_b16 a[82:83], v224 offset:63488
    v_mfma_f32_16x16x32_bf16 a[20:23], a[84:87], v[116:119], a[20:23]
    v_mfma_f32_16x16x32_bf16 a[36:39], a[84:87], v[120:123], a[36:39]
    s_waitcnt lgkmcnt(10)
    v_mfma_f32_16x16x32_bf16 a[52:55], a[84:87], v[124:127], a[52:55]
    ds_read_b64_tr_b16 a[84:85], v225 offset:61440
    v_mfma_f32_16x16x32_bf16 a[8:11], a[88:91], v[112:115], a[8:11]
    ds_read_b64_tr_b16 a[86:87], v225 offset:63488
    v_mfma_f32_16x16x32_bf16 a[24:27], a[88:91], v[116:119], a[24:27]
    v_mfma_f32_16x16x32_bf16 a[40:43], a[88:91], v[120:123], a[40:43]
    v_mfma_f32_16x16x32_bf16 a[56:59], a[88:91], v[124:127], a[56:59]
    ds_read_b64_tr_b16 a[88:89], v226 offset:61440
    v_mfma_f32_16x16x32_bf16 a[12:15], a[92:95], v[112:115], a[12:15]
    ds_read_b64_tr_b16 a[90:91], v226 offset:63488
    v_mfma_f32_16x16x32_bf16 a[28:31], a[92:95], v[116:119], a[28:31]
    v_mfma_f32_16x16x32_bf16 a[44:47], a[92:95], v[120:123], a[44:47]
    s_waitcnt lgkmcnt(10)
    v_mfma_f32_16x16x32_bf16 a[60:63], a[92:95], v[124:127], a[60:63]
    ds_read_b64_tr_b16 a[92:93], v227 offset:61440
    v_mfma_f32_16x16x32_bf16 a[0:3], a[64:67], v[128:131], a[0:3]
    ds_read_b64_tr_b16 a[94:95], v227 offset:63488
    v_mfma_f32_16x16x32_bf16 a[16:19], a[64:67], v[132:135], a[16:19]
    v_mfma_f32_16x16x32_bf16 a[32:35], a[64:67], v[136:139], a[32:35]
    v_mfma_f32_16x16x32_bf16 a[48:51], a[64:67], v[140:143], a[48:51]
    s_waitcnt vmcnt(12)
    s_barrier
    v_add_u32 v224, 0x10000, v224
    ds_read_b64_tr_b16 a[64:65], v224 offset:0
    v_mfma_f32_16x16x32_bf16 a[4:7], a[68:71], v[128:131], a[4:7]
    ds_read_b64_tr_b16 a[66:67], v224 offset:2048
    v_mfma_f32_16x16x32_bf16 a[20:23], a[68:71], v[132:135], a[20:23]
    v_mfma_f32_16x16x32_bf16 a[36:39], a[68:71], v[136:139], a[36:39]
    s_waitcnt lgkmcnt(10)
    v_mfma_f32_16x16x32_bf16 a[52:55], a[68:71], v[140:143], a[52:55]
    v_add_u32 v225, 0x10000, v225
    ds_read_b64_tr_b16 a[68:69], v225 offset:0
    v_mfma_f32_16x16x32_bf16 a[8:11], a[72:75], v[128:131], a[8:11]
    ds_read_b64_tr_b16 a[70:71], v225 offset:2048
    v_mfma_f32_16x16x32_bf16 a[24:27], a[72:75], v[132:135], a[24:27]
    v_mfma_f32_16x16x32_bf16 a[40:43], a[72:75], v[136:139], a[40:43]
    v_mfma_f32_16x16x32_bf16 a[56:59], a[72:75], v[140:143], a[56:59]
    v_add_u32 v226, 0x10000, v226
    ds_read_b64_tr_b16 a[72:73], v226 offset:0
    v_mfma_f32_16x16x32_bf16 a[12:15], a[76:79], v[128:131], a[12:15]
    ds_read_b64_tr_b16 a[74:75], v226 offset:2048
    v_mfma_f32_16x16x32_bf16 a[28:31], a[76:79], v[132:135], a[28:31]
    v_mfma_f32_16x16x32_bf16 a[44:47], a[76:79], v[136:139], a[44:47]
    s_waitcnt lgkmcnt(10)
    v_mfma_f32_16x16x32_bf16 a[60:63], a[76:79], v[140:143], a[60:63]
    v_add_u32 v227, 0x10000, v227
    ds_read_b64_tr_b16 a[76:77], v227 offset:0
    v_mfma_f32_16x16x32_bf16 a[0:3], a[80:83], v[144:147], a[0:3]
    ds_read_b64_tr_b16 a[78:79], v227 offset:2048
    v_mfma_f32_16x16x32_bf16 a[16:19], a[80:83], v[148:151], a[16:19]
    v_mfma_f32_16x16x32_bf16 a[32:35], a[80:83], v[152:155], a[32:35]
    v_mfma_f32_16x16x32_bf16 a[48:51], a[80:83], v[156:159], a[48:51]
    ds_read_b64_tr_b16 a[80:81], v224 offset:4096
    v_mfma_f32_16x16x32_bf16 a[4:7], a[84:87], v[144:147], a[4:7]
    ds_read_b64_tr_b16 a[82:83], v224 offset:6144
    v_mfma_f32_16x16x32_bf16 a[20:23], a[84:87], v[148:151], a[20:23]
    v_mfma_f32_16x16x32_bf16 a[36:39], a[84:87], v[152:155], a[36:39]
    s_waitcnt lgkmcnt(10)
    v_mfma_f32_16x16x32_bf16 a[52:55], a[84:87], v[156:159], a[52:55]
    ds_read_b64_tr_b16 a[84:85], v225 offset:4096
    v_mfma_f32_16x16x32_bf16 a[8:11], a[88:91], v[144:147], a[8:11]
    ds_read_b64_tr_b16 a[86:87], v225 offset:6144
    v_mfma_f32_16x16x32_bf16 a[24:27], a[88:91], v[148:151], a[24:27]
    v_mfma_f32_16x16x32_bf16 a[40:43], a[88:91], v[152:155], a[40:43]
    v_mfma_f32_16x16x32_bf16 a[56:59], a[88:91], v[156:159], a[56:59]
    ds_read_b64_tr_b16 a[88:89], v226 offset:4096
    v_mfma_f32_16x16x32_bf16 a[12:15], a[92:95], v[144:147], a[12:15]
    ds_read_b64_tr_b16 a[90:91], v226 offset:6144
    v_mfma_f32_16x16x32_bf16 a[28:31], a[92:95], v[148:151], a[28:31]
    v_mfma_f32_16x16x32_bf16 a[44:47], a[92:95], v[152:155], a[44:47]
    s_waitcnt lgkmcnt(10)
    v_mfma_f32_16x16x32_bf16 a[60:63], a[92:95], v[156:159], a[60:63]
    ds_read_b64_tr_b16 a[92:93], v227 offset:4096
    v_mfma_f32_16x16x32_bf16 v[160:163], a[64:67], a[96:99], 0
    ds_read_b64_tr_b16 a[94:95], v227 offset:6144
    v_mfma_f32_16x16x32_bf16 v[176:179], a[64:67], a[100:103], 0
    v_mfma_f32_16x16x32_bf16 v[192:195], a[64:67], a[104:107], 0
    v_mfma_f32_16x16x32_bf16 v[208:211], a[64:67], a[108:111], 0
    ds_read_b64_tr_b16 a[64:65], v224 offset:8192
    v_mfma_f32_16x16x32_bf16 v[164:167], a[68:71], a[96:99], 0
    ds_read_b64_tr_b16 a[66:67], v224 offset:10240
    v_mfma_f32_16x16x32_bf16 v[180:183], a[68:71], a[100:103], 0
    v_mfma_f32_16x16x32_bf16 v[196:199], a[68:71], a[104:107], 0
    s_waitcnt lgkmcnt(10)
    v_accvgpr_read_b32 v250, a0
    v_accvgpr_read_b32 v251, a1
    v_mfma_f32_16x16x32_bf16 v[212:215], a[68:71], a[108:111], 0
    ds_read_b64_tr_b16 a[68:69], v225 offset:8192
    v_accvgpr_read_b32 v252, a2
    v_mfma_f32_16x16x32_bf16 v[168:171], a[72:75], a[96:99], 0
    ds_read_b64_tr_b16 a[70:71], v225 offset:10240
    v_accvgpr_read_b32 v253, a3
    v_mfma_f32_16x16x32_bf16 v[184:187], a[72:75], a[100:103], 0
    v_mul_f32 v250, v242, v250
    v_mul_f32 v251, v242, v251
    v_mfma_f32_16x16x32_bf16 v[200:203], a[72:75], a[104:107], 0
    v_mul_f32 v252, v242, v252
    v_mul_f32 v253, v242, v253
    v_mfma_f32_16x16x32_bf16 v[216:219], a[72:75], a[108:111], 0
    ds_read_b64_tr_b16 a[72:73], v226 offset:8192
    v_cvt_pk_bf16_f32 v250, v250, v251
    v_mfma_f32_16x16x32_bf16 v[172:175], a[76:79], a[96:99], 0
    ds_read_b64_tr_b16 a[74:75], v226 offset:10240
    v_cvt_pk_bf16_f32 v251, v252, v253
    v_mfma_f32_16x16x32_bf16 v[188:191], a[76:79], a[100:103], 0
    ds_write_b64 v246, v[250:251] offset:0
    v_mfma_f32_16x16x32_bf16 v[204:207], a[76:79], a[104:107], 0
    s_waitcnt lgkmcnt(11)
    v_accvgpr_read_b32 v250, a4
    v_accvgpr_read_b32 v251, a5
    v_mfma_f32_16x16x32_bf16 v[220:223], a[76:79], a[108:111], 0
    ds_read_b64_tr_b16 a[76:77], v227 offset:8192
    v_accvgpr_read_b32 v252, a6
    v_mfma_f32_16x16x32_bf16 v[160:163], a[80:83], a[112:115], v[160:163]
    ds_read_b64_tr_b16 a[78:79], v227 offset:10240
    v_accvgpr_read_b32 v253, a7
    v_mfma_f32_16x16x32_bf16 v[176:179], a[80:83], a[116:119], v[176:179]
    v_mul_f32 v250, v242, v250
    v_mul_f32 v251, v242, v251
    v_mfma_f32_16x16x32_bf16 v[192:195], a[80:83], a[120:123], v[192:195]
    v_mul_f32 v252, v242, v252
    v_mul_f32 v253, v242, v253
    v_mfma_f32_16x16x32_bf16 v[208:211], a[80:83], a[124:127], v[208:211]
    ds_read_b64_tr_b16 a[80:81], v224 offset:12288
    v_cvt_pk_bf16_f32 v250, v250, v251
    v_mfma_f32_16x16x32_bf16 v[164:167], a[84:87], a[112:115], v[164:167]
    ds_read_b64_tr_b16 a[82:83], v224 offset:14336
    v_cvt_pk_bf16_f32 v251, v252, v253
    v_mfma_f32_16x16x32_bf16 v[180:183], a[84:87], a[116:119], v[180:183]
    ds_write_b64 v247, v[250:251] offset:0
    v_mfma_f32_16x16x32_bf16 v[196:199], a[84:87], a[120:123], v[196:199]
    s_waitcnt lgkmcnt(12)
    v_accvgpr_read_b32 v250, a8
    v_accvgpr_read_b32 v251, a9
    v_mfma_f32_16x16x32_bf16 v[212:215], a[84:87], a[124:127], v[212:215]
    ds_read_b64_tr_b16 a[84:85], v225 offset:12288
    v_accvgpr_read_b32 v252, a10
    v_mfma_f32_16x16x32_bf16 v[168:171], a[88:91], a[112:115], v[168:171]
    ds_read_b64_tr_b16 a[86:87], v225 offset:14336
    v_accvgpr_read_b32 v253, a11
    v_mfma_f32_16x16x32_bf16 v[184:187], a[88:91], a[116:119], v[184:187]
    v_mul_f32 v250, v242, v250
    v_mul_f32 v251, v242, v251
    v_mfma_f32_16x16x32_bf16 v[200:203], a[88:91], a[120:123], v[200:203]
    v_mul_f32 v252, v242, v252
    v_mul_f32 v253, v242, v253
    v_mfma_f32_16x16x32_bf16 v[216:219], a[88:91], a[124:127], v[216:219]
    ds_read_b64_tr_b16 a[88:89], v226 offset:12288
    v_cvt_pk_bf16_f32 v250, v250, v251
    v_mfma_f32_16x16x32_bf16 v[172:175], a[92:95], a[112:115], v[172:175]
    ds_read_b64_tr_b16 a[90:91], v226 offset:14336
    v_cvt_pk_bf16_f32 v251, v252, v253
    v_mfma_f32_16x16x32_bf16 v[188:191], a[92:95], a[116:119], v[188:191]
    ds_write_b64 v248, v[250:251] offset:0
    v_mfma_f32_16x16x32_bf16 v[204:207], a[92:95], a[120:123], v[204:207]
    s_waitcnt lgkmcnt(13)
    v_accvgpr_read_b32 v250, a12
    v_accvgpr_read_b32 v251, a13
    v_mfma_f32_16x16x32_bf16 v[220:223], a[92:95], a[124:127], v[220:223]
    ds_read_b64_tr_b16 a[92:93], v227 offset:12288
    v_accvgpr_read_b32 v252, a14
    v_mfma_f32_16x16x32_bf16 v[160:163], a[64:67], a[128:131], v[160:163]
    ds_read_b64_tr_b16 a[94:95], v227 offset:14336
    v_accvgpr_read_b32 v253, a15
    v_mfma_f32_16x16x32_bf16 v[176:179], a[64:67], a[132:135], v[176:179]
    v_mul_f32 v250, v242, v250
    v_mul_f32 v251, v242, v251
    v_mfma_f32_16x16x32_bf16 v[192:195], a[64:67], a[136:139], v[192:195]
    v_mul_f32 v252, v242, v252
    v_mul_f32 v253, v242, v253
    v_mfma_f32_16x16x32_bf16 v[208:211], a[64:67], a[140:143], v[208:211]
    s_waitcnt vmcnt(8)
    s_barrier
    ds_read_b64_tr_b16 a[64:65], v224 offset:16384
    v_mfma_f32_16x16x32_bf16 v[164:167], a[68:71], a[128:131], v[164:167]
    ds_read_b64_tr_b16 a[66:67], v224 offset:18432
    v_cvt_pk_bf16_f32 v250, v250, v251
    v_mfma_f32_16x16x32_bf16 v[180:183], a[68:71], a[132:135], v[180:183]
    v_cvt_pk_bf16_f32 v251, v252, v253
    v_mfma_f32_16x16x32_bf16 v[196:199], a[68:71], a[136:139], v[196:199]
    s_waitcnt lgkmcnt(12)
    v_mfma_f32_16x16x32_bf16 v[212:215], a[68:71], a[140:143], v[212:215]
    ds_read_b64_tr_b16 a[68:69], v225 offset:16384
    v_mfma_f32_16x16x32_bf16 v[168:171], a[72:75], a[128:131], v[168:171]
    ds_read_b64_tr_b16 a[70:71], v225 offset:18432
    v_mfma_f32_16x16x32_bf16 v[184:187], a[72:75], a[132:135], v[184:187]
    ds_write_b64 v249, v[250:251] offset:0
    v_mfma_f32_16x16x32_bf16 v[200:203], a[72:75], a[136:139], v[200:203]
    ds_read_b128 a[0:3], v239 offset:0
    v_mfma_f32_16x16x32_bf16 v[216:219], a[72:75], a[140:143], v[216:219]
    ds_read_b64_tr_b16 a[72:73], v226 offset:16384
    v_mfma_f32_16x16x32_bf16 v[172:175], a[76:79], a[128:131], v[172:175]
    ds_read_b64_tr_b16 a[74:75], v226 offset:18432
    v_mfma_f32_16x16x32_bf16 v[188:191], a[76:79], a[132:135], v[188:191]
    ds_read_b128 a[4:7], v239 offset:1024
    v_accvgpr_read_b32 v250, a16
    v_mfma_f32_16x16x32_bf16 v[204:207], a[76:79], a[136:139], v[204:207]
    s_waitcnt lgkmcnt(14)
    v_accvgpr_read_b32 v251, a17
    v_accvgpr_read_b32 v252, a18
    v_mfma_f32_16x16x32_bf16 v[220:223], a[76:79], a[140:143], v[220:223]
    ds_read_b64_tr_b16 a[76:77], v227 offset:16384
    v_accvgpr_read_b32 v253, a19
    v_mfma_f32_16x16x32_bf16 v[160:163], a[80:83], a[144:147], v[160:163]
    ds_read_b64_tr_b16 a[78:79], v227 offset:18432
    v_mul_f32 v250, v243, v250
    v_mfma_f32_16x16x32_bf16 v[176:179], a[80:83], a[148:151], v[176:179]
    v_mul_f32 v251, v243, v251
    v_mul_f32 v252, v243, v252
    v_mfma_f32_16x16x32_bf16 v[192:195], a[80:83], a[152:155], v[192:195]
    v_mul_f32 v253, v243, v253
    v_mfma_f32_16x16x32_bf16 v[208:211], a[80:83], a[156:159], v[208:211]
    ds_read_b64_tr_b16 a[80:81], v224 offset:20480
    v_mfma_f32_16x16x32_bf16 v[164:167], a[84:87], a[144:147], v[164:167]
    ds_read_b64_tr_b16 a[82:83], v224 offset:22528
    v_mfma_f32_16x16x32_bf16 v[180:183], a[84:87], a[148:151], v[180:183]
    s_waitcnt lgkmcnt(7)
    v_mfma_f32_16x16x32_bf16 v[196:199], a[84:87], a[152:155], v[196:199]
    buffer_store_dwordx4 a[0:3], v240, s[24:27], s31 offen sc0 sc1 nt
    v_mfma_f32_16x16x32_bf16 v[212:215], a[84:87], a[156:159], v[212:215]
    ds_read_b64_tr_b16 a[84:85], v225 offset:20480
    v_cvt_pk_bf16_f32 v250, v250, v251
    v_mfma_f32_16x16x32_bf16 v[168:171], a[88:91], a[144:147], v[168:171]
    ds_read_b64_tr_b16 a[86:87], v225 offset:22528
    v_cvt_pk_bf16_f32 v251, v252, v253
    v_mfma_f32_16x16x32_bf16 v[184:187], a[88:91], a[148:151], v[184:187]
    ds_write_b64 v246, v[250:251] offset:2048
    v_mfma_f32_16x16x32_bf16 v[200:203], a[88:91], a[152:155], v[200:203]
    v_accvgpr_read_b32 v250, a20
    v_accvgpr_read_b32 v251, a21
    v_mfma_f32_16x16x32_bf16 v[216:219], a[88:91], a[156:159], v[216:219]
    ds_read_b64_tr_b16 a[88:89], v226 offset:20480
    v_accvgpr_read_b32 v252, a22
    v_mfma_f32_16x16x32_bf16 v[172:175], a[92:95], a[144:147], v[172:175]
    ds_read_b64_tr_b16 a[90:91], v226 offset:22528
    v_accvgpr_read_b32 v253, a23
    v_mfma_f32_16x16x32_bf16 v[188:191], a[92:95], a[148:151], v[188:191]
    v_mul_f32 v250, v243, v250
    v_mul_f32 v251, v243, v251
    v_mfma_f32_16x16x32_bf16 v[204:207], a[92:95], a[152:155], v[204:207]
    v_mul_f32 v252, v243, v252
    v_mul_f32 v253, v243, v253
    v_mfma_f32_16x16x32_bf16 v[220:223], a[92:95], a[156:159], v[220:223]
    ds_read_b64_tr_b16 a[92:93], v227 offset:20480
    v_cvt_pk_bf16_f32 v250, v250, v251
    v_mfma_f32_16x16x32_bf16 v[160:163], a[64:67], a[160:163], v[160:163]
    ds_read_b64_tr_b16 a[94:95], v227 offset:22528
    v_mfma_f32_16x16x32_bf16 v[176:179], a[64:67], a[164:167], v[176:179]
    s_waitcnt lgkmcnt(11)
    v_mfma_f32_16x16x32_bf16 v[192:195], a[64:67], a[168:171], v[192:195]
    buffer_store_dwordx4 a[4:7], v240, s[24:27], s31 offen offset:2048 sc0 sc1 nt
    v_mfma_f32_16x16x32_bf16 v[208:211], a[64:67], a[172:175], v[208:211]
    ds_read_b64_tr_b16 a[64:65], v224 offset:24576
    v_cvt_pk_bf16_f32 v251, v252, v253
    v_mfma_f32_16x16x32_bf16 v[164:167], a[68:71], a[160:163], v[164:167]
    ds_read_b64_tr_b16 a[66:67], v224 offset:26624
    v_mfma_f32_16x16x32_bf16 v[180:183], a[68:71], a[164:167], v[180:183]
    ds_write_b64 v247, v[250:251] offset:2048
    v_mfma_f32_16x16x32_bf16 v[196:199], a[68:71], a[168:171], v[196:199]
    s_waitcnt lgkmcnt(12)
    v_accvgpr_read_b32 v250, a24
    v_accvgpr_read_b32 v251, a25
    v_mfma_f32_16x16x32_bf16 v[212:215], a[68:71], a[172:175], v[212:215]
    ds_read_b64_tr_b16 a[68:69], v225 offset:24576
    v_accvgpr_read_b32 v252, a26
    v_mfma_f32_16x16x32_bf16 v[168:171], a[72:75], a[160:163], v[168:171]
    ds_read_b64_tr_b16 a[70:71], v225 offset:26624
    v_accvgpr_read_b32 v253, a27
    v_mfma_f32_16x16x32_bf16 v[184:187], a[72:75], a[164:167], v[184:187]
    v_mul_f32 v250, v243, v250
    v_mul_f32 v251, v243, v251
    v_mfma_f32_16x16x32_bf16 v[200:203], a[72:75], a[168:171], v[200:203]
    v_mul_f32 v252, v243, v252
    v_mul_f32 v253, v243, v253
    v_mfma_f32_16x16x32_bf16 v[216:219], a[72:75], a[172:175], v[216:219]
    ds_read_b64_tr_b16 a[72:73], v226 offset:24576
    v_cvt_pk_bf16_f32 v250, v250, v251
    v_mfma_f32_16x16x32_bf16 v[172:175], a[76:79], a[160:163], v[172:175]
    ds_read_b64_tr_b16 a[74:75], v226 offset:26624
    v_cvt_pk_bf16_f32 v251, v252, v253
    v_mfma_f32_16x16x32_bf16 v[188:191], a[76:79], a[164:167], v[188:191]
    ds_write_b64 v248, v[250:251] offset:2048
    v_mfma_f32_16x16x32_bf16 v[204:207], a[76:79], a[168:171], v[204:207]
    s_waitcnt lgkmcnt(13)
    v_accvgpr_read_b32 v250, a28
    v_accvgpr_read_b32 v251, a29
    v_mfma_f32_16x16x32_bf16 v[220:223], a[76:79], a[172:175], v[220:223]
    ds_read_b64_tr_b16 a[76:77], v227 offset:24576
    v_accvgpr_read_b32 v252, a30
    v_mfma_f32_16x16x32_bf16 v[160:163], a[80:83], a[176:179], v[160:163]
    ds_read_b64_tr_b16 a[78:79], v227 offset:26624
    v_accvgpr_read_b32 v253, a31
    v_mfma_f32_16x16x32_bf16 v[176:179], a[80:83], a[180:183], v[176:179]
    v_mul_f32 v250, v243, v250
    v_mul_f32 v251, v243, v251
    v_mfma_f32_16x16x32_bf16 v[192:195], a[80:83], a[184:187], v[192:195]
    v_mul_f32 v252, v243, v252
    v_mul_f32 v253, v243, v253
    v_mfma_f32_16x16x32_bf16 v[208:211], a[80:83], a[188:191], v[208:211]
    ds_read_b64_tr_b16 a[80:81], v224 offset:28672
    v_cvt_pk_bf16_f32 v250, v250, v251
    v_mfma_f32_16x16x32_bf16 v[164:167], a[84:87], a[176:179], v[164:167]
    ds_read_b64_tr_b16 a[82:83], v224 offset:30720
    v_cvt_pk_bf16_f32 v251, v252, v253
    v_mfma_f32_16x16x32_bf16 v[180:183], a[84:87], a[180:183], v[180:183]
    ds_write_b64 v249, v[250:251] offset:2048
    v_mfma_f32_16x16x32_bf16 v[196:199], a[84:87], a[184:187], v[196:199]
    s_waitcnt lgkmcnt(13)
    v_mfma_f32_16x16x32_bf16 v[212:215], a[84:87], a[188:191], v[212:215]
    ds_read_b64_tr_b16 a[84:85], v225 offset:28672
    v_mfma_f32_16x16x32_bf16 v[168:171], a[88:91], a[176:179], v[168:171]
    ds_read_b64_tr_b16 a[86:87], v225 offset:30720
    v_mfma_f32_16x16x32_bf16 v[184:187], a[88:91], a[180:183], v[184:187]
    ds_read_b128 a[16:19], v239 offset:2048
    v_mfma_f32_16x16x32_bf16 v[200:203], a[88:91], a[184:187], v[200:203]
    ds_read_b128 a[20:23], v239 offset:3072
    v_accvgpr_read_b32 v250, a32
    v_mfma_f32_16x16x32_bf16 v[216:219], a[88:91], a[188:191], v[216:219]
    ds_read_b64_tr_b16 a[88:89], v226 offset:28672
    v_accvgpr_read_b32 v251, a33
    v_mfma_f32_16x16x32_bf16 v[172:175], a[92:95], a[176:179], v[172:175]
    ds_read_b64_tr_b16 a[90:91], v226 offset:30720
    v_accvgpr_read_b32 v252, a34
    v_mfma_f32_16x16x32_bf16 v[188:191], a[92:95], a[180:183], v[188:191]
    v_accvgpr_read_b32 v253, a35
    v_mul_f32 v250, v244, v250
    v_mfma_f32_16x16x32_bf16 v[204:207], a[92:95], a[184:187], v[204:207]
    s_waitcnt lgkmcnt(14)
    v_mul_f32 v251, v244, v251
    v_mul_f32 v252, v244, v252
    v_mfma_f32_16x16x32_bf16 v[220:223], a[92:95], a[188:191], v[220:223]
    ds_read_b64_tr_b16 a[92:93], v227 offset:28672
    v_mul_f32 v253, v244, v253
    v_mfma_f32_16x16x32_bf16 v[160:163], a[64:67], v[0:3], v[160:163]
    ds_read_b64_tr_b16 a[94:95], v227 offset:30720
    v_mfma_f32_16x16x32_bf16 v[176:179], a[64:67], v[4:7], v[176:179]
    s_waitcnt lgkmcnt(5)
    v_mfma_f32_16x16x32_bf16 v[192:195], a[64:67], v[8:11], v[192:195]
    buffer_store_dwordx4 a[16:19], v240, s[24:27], s34 offen sc0 sc1 nt
    v_mfma_f32_16x16x32_bf16 v[208:211], a[64:67], v[12:15], v[208:211]
    s_waitcnt vmcnt(7)
    s_barrier
    ds_read_b64_tr_b16 a[64:65], v224 offset:32768
    v_mfma_f32_16x16x32_bf16 v[164:167], a[68:71], v[0:3], v[164:167]
    ds_read_b64_tr_b16 a[66:67], v224 offset:34816
    v_cvt_pk_bf16_f32 v250, v250, v251
    v_mfma_f32_16x16x32_bf16 v[180:183], a[68:71], v[4:7], v[180:183]
    v_cvt_pk_bf16_f32 v251, v252, v253
    v_mfma_f32_16x16x32_bf16 v[196:199], a[68:71], v[8:11], v[196:199]
    ds_write_b64 v246, v[250:251] offset:4096
    v_mfma_f32_16x16x32_bf16 v[212:215], a[68:71], v[12:15], v[212:215]
    ds_read_b64_tr_b16 a[68:69], v225 offset:32768
    v_accvgpr_read_b32 v250, a36
    v_mfma_f32_16x16x32_bf16 v[168:171], a[72:75], v[0:3], v[168:171]
    ds_read_b64_tr_b16 a[70:71], v225 offset:34816
    v_accvgpr_read_b32 v251, a37
    v_mfma_f32_16x16x32_bf16 v[184:187], a[72:75], v[4:7], v[184:187]
    v_accvgpr_read_b32 v252, a38
    v_accvgpr_read_b32 v253, a39
    v_mfma_f32_16x16x32_bf16 v[200:203], a[72:75], v[8:11], v[200:203]
    v_mul_f32 v250, v244, v250
    v_mul_f32 v251, v244, v251
    v_mfma_f32_16x16x32_bf16 v[216:219], a[72:75], v[12:15], v[216:219]
    ds_read_b64_tr_b16 a[72:73], v226 offset:32768
    v_mul_f32 v252, v244, v252
    v_mfma_f32_16x16x32_bf16 v[172:175], a[76:79], v[0:3], v[172:175]
    ds_read_b64_tr_b16 a[74:75], v226 offset:34816
    v_mul_f32 v253, v244, v253
    v_mfma_f32_16x16x32_bf16 v[188:191], a[76:79], v[4:7], v[188:191]
    v_cvt_pk_bf16_f32 v250, v250, v251
    v_mfma_f32_16x16x32_bf16 v[204:207], a[76:79], v[8:11], v[204:207]
    s_waitcnt lgkmcnt(11)
    v_mfma_f32_16x16x32_bf16 v[220:223], a[76:79], v[12:15], v[220:223]
    ds_read_b64_tr_b16 a[76:77], v227 offset:32768
    v_mfma_f32_16x16x32_bf16 v[160:163], a[80:83], v[16:19], v[160:163]
    ds_read_b64_tr_b16 a[78:79], v227 offset:34816
    v_mfma_f32_16x16x32_bf16 v[176:179], a[80:83], v[20:23], v[176:179]
    buffer_store_dwordx4 a[20:23], v240, s[24:27], s34 offen offset:2048 sc0 sc1 nt
    v_mfma_f32_16x16x32_bf16 v[192:195], a[80:83], v[24:27], v[192:195]
    v_cvt_pk_bf16_f32 v251, v252, v253
    v_mfma_f32_16x16x32_bf16 v[208:211], a[80:83], v[28:31], v[208:211]
    ds_read_b64_tr_b16 a[80:81], v224 offset:36864
    v_mfma_f32_16x16x32_bf16 v[164:167], a[84:87], v[16:19], v[164:167]
    ds_read_b64_tr_b16 a[82:83], v224 offset:38912
    v_mfma_f32_16x16x32_bf16 v[180:183], a[84:87], v[20:23], v[180:183]
    ds_write_b64 v247, v[250:251] offset:4096
    v_mfma_f32_16x16x32_bf16 v[196:199], a[84:87], v[24:27], v[196:199]
    s_waitcnt lgkmcnt(12)
    v_accvgpr_read_b32 v250, a40
    v_accvgpr_read_b32 v251, a41
    v_mfma_f32_16x16x32_bf16 v[212:215], a[84:87], v[28:31], v[212:215]
    ds_read_b64_tr_b16 a[84:85], v225 offset:36864
    v_accvgpr_read_b32 v252, a42
    v_mfma_f32_16x16x32_bf16 v[168:171], a[88:91], v[16:19], v[168:171]
    ds_read_b64_tr_b16 a[86:87], v225 offset:38912
    v_accvgpr_read_b32 v253, a43
    v_mfma_f32_16x16x32_bf16 v[184:187], a[88:91], v[20:23], v[184:187]
    v_mul_f32 v250, v244, v250
    v_mul_f32 v251, v244, v251
    v_mfma_f32_16x16x32_bf16 v[200:203], a[88:91], v[24:27], v[200:203]
    v_mul_f32 v252, v244, v252
    v_mul_f32 v253, v244, v253
    v_mfma_f32_16x16x32_bf16 v[216:219], a[88:91], v[28:31], v[216:219]
    ds_read_b64_tr_b16 a[88:89], v226 offset:36864
    v_cvt_pk_bf16_f32 v250, v250, v251
    v_mfma_f32_16x16x32_bf16 v[172:175], a[92:95], v[16:19], v[172:175]
    ds_read_b64_tr_b16 a[90:91], v226 offset:38912
    v_cvt_pk_bf16_f32 v251, v252, v253
    v_mfma_f32_16x16x32_bf16 v[188:191], a[92:95], v[20:23], v[188:191]
    ds_write_b64 v248, v[250:251] offset:4096
    v_mfma_f32_16x16x32_bf16 v[204:207], a[92:95], v[24:27], v[204:207]
    s_waitcnt lgkmcnt(12)
    v_accvgpr_read_b32 v250, a44
    v_accvgpr_read_b32 v251, a45
    v_mfma_f32_16x16x32_bf16 v[220:223], a[92:95], v[28:31], v[220:223]
    ds_read_b64_tr_b16 a[92:93], v227 offset:36864
    v_accvgpr_read_b32 v252, a46
    v_mfma_f32_16x16x32_bf16 v[160:163], a[64:67], v[32:35], v[160:163]
    ds_read_b64_tr_b16 a[94:95], v227 offset:38912
    v_accvgpr_read_b32 v253, a47
    v_mfma_f32_16x16x32_bf16 v[176:179], a[64:67], v[36:39], v[176:179]
    v_mul_f32 v250, v244, v250
    v_mul_f32 v251, v244, v251
    v_mfma_f32_16x16x32_bf16 v[192:195], a[64:67], v[40:43], v[192:195]
    v_mul_f32 v252, v244, v252
    v_mul_f32 v253, v244, v253
    v_mfma_f32_16x16x32_bf16 v[208:211], a[64:67], v[44:47], v[208:211]
    ds_read_b64_tr_b16 a[64:65], v224 offset:40960
    v_cvt_pk_bf16_f32 v250, v250, v251
    v_mfma_f32_16x16x32_bf16 v[164:167], a[68:71], v[32:35], v[164:167]
    ds_read_b64_tr_b16 a[66:67], v224 offset:43008
    v_cvt_pk_bf16_f32 v251, v252, v253
    v_mfma_f32_16x16x32_bf16 v[180:183], a[68:71], v[36:39], v[180:183]
    ds_write_b64 v249, v[250:251] offset:4096
    v_mfma_f32_16x16x32_bf16 v[196:199], a[68:71], v[40:43], v[196:199]
    s_waitcnt lgkmcnt(13)
    v_mfma_f32_16x16x32_bf16 v[212:215], a[68:71], v[44:47], v[212:215]
    ds_read_b64_tr_b16 a[68:69], v225 offset:40960
    v_mfma_f32_16x16x32_bf16 v[168:171], a[72:75], v[32:35], v[168:171]
    ds_read_b64_tr_b16 a[70:71], v225 offset:43008
    v_mfma_f32_16x16x32_bf16 v[184:187], a[72:75], v[36:39], v[184:187]
    ds_read_b128 a[32:35], v239 offset:4096
    v_mfma_f32_16x16x32_bf16 v[200:203], a[72:75], v[40:43], v[200:203]
    ds_read_b128 a[36:39], v239 offset:5120
    v_accvgpr_read_b32 v250, a48
    v_mfma_f32_16x16x32_bf16 v[216:219], a[72:75], v[44:47], v[216:219]
    ds_read_b64_tr_b16 a[72:73], v226 offset:40960
    v_accvgpr_read_b32 v251, a49
    v_mfma_f32_16x16x32_bf16 v[172:175], a[76:79], v[32:35], v[172:175]
    ds_read_b64_tr_b16 a[74:75], v226 offset:43008
    v_accvgpr_read_b32 v252, a50
    v_mfma_f32_16x16x32_bf16 v[188:191], a[76:79], v[36:39], v[188:191]
    v_accvgpr_read_b32 v253, a51
    v_mul_f32 v250, v245, v250
    v_mfma_f32_16x16x32_bf16 v[204:207], a[76:79], v[40:43], v[204:207]
    s_waitcnt lgkmcnt(14)
    v_mul_f32 v251, v245, v251
    v_mul_f32 v252, v245, v252
    v_mfma_f32_16x16x32_bf16 v[220:223], a[76:79], v[44:47], v[220:223]
    ds_read_b64_tr_b16 a[76:77], v227 offset:40960
    v_mul_f32 v253, v245, v253
    v_mfma_f32_16x16x32_bf16 v[160:163], a[80:83], v[48:51], v[160:163]
    ds_read_b64_tr_b16 a[78:79], v227 offset:43008
    v_mfma_f32_16x16x32_bf16 v[176:179], a[80:83], v[52:55], v[176:179]
    s_waitcnt lgkmcnt(5)
    v_mfma_f32_16x16x32_bf16 v[192:195], a[80:83], v[56:59], v[192:195]
    buffer_store_dwordx4 a[32:35], v240, s[24:27], s35 offen sc0 sc1 nt
    v_mfma_f32_16x16x32_bf16 v[208:211], a[80:83], v[60:63], v[208:211]
    ds_read_b64_tr_b16 a[80:81], v224 offset:45056
    v_cvt_pk_bf16_f32 v250, v250, v251
    v_mfma_f32_16x16x32_bf16 v[164:167], a[84:87], v[48:51], v[164:167]
    ds_read_b64_tr_b16 a[82:83], v224 offset:47104
    v_cvt_pk_bf16_f32 v251, v252, v253
    v_mfma_f32_16x16x32_bf16 v[180:183], a[84:87], v[52:55], v[180:183]
    ds_write_b64 v246, v[250:251] offset:6144
    v_mfma_f32_16x16x32_bf16 v[196:199], a[84:87], v[56:59], v[196:199]
    v_accvgpr_read_b32 v250, a52
    v_accvgpr_read_b32 v251, a53
    v_mfma_f32_16x16x32_bf16 v[212:215], a[84:87], v[60:63], v[212:215]
    ds_read_b64_tr_b16 a[84:85], v225 offset:45056
    v_accvgpr_read_b32 v252, a54
    v_mfma_f32_16x16x32_bf16 v[168:171], a[88:91], v[48:51], v[168:171]
    ds_read_b64_tr_b16 a[86:87], v225 offset:47104
    v_accvgpr_read_b32 v253, a55
    v_mfma_f32_16x16x32_bf16 v[184:187], a[88:91], v[52:55], v[184:187]
    v_mul_f32 v250, v245, v250
    v_mul_f32 v251, v245, v251
    v_mfma_f32_16x16x32_bf16 v[200:203], a[88:91], v[56:59], v[200:203]
    v_mul_f32 v252, v245, v252
    v_mul_f32 v253, v245, v253
    v_mfma_f32_16x16x32_bf16 v[216:219], a[88:91], v[60:63], v[216:219]
    ds_read_b64_tr_b16 a[88:89], v226 offset:45056
    v_cvt_pk_bf16_f32 v250, v250, v251
    v_mfma_f32_16x16x32_bf16 v[172:175], a[92:95], v[48:51], v[172:175]
    ds_read_b64_tr_b16 a[90:91], v226 offset:47104
    v_mfma_f32_16x16x32_bf16 v[188:191], a[92:95], v[52:55], v[188:191]
    s_waitcnt lgkmcnt(11)
    v_mfma_f32_16x16x32_bf16 v[204:207], a[92:95], v[56:59], v[204:207]
    buffer_store_dwordx4 a[36:39], v240, s[24:27], s35 offen offset:2048 sc0 sc1 nt
    v_mfma_f32_16x16x32_bf16 v[220:223], a[92:95], v[60:63], v[220:223]
    ds_read_b64_tr_b16 a[92:93], v227 offset:45056
    v_cvt_pk_bf16_f32 v251, v252, v253
    v_mfma_f32_16x16x32_bf16 v[160:163], a[64:67], v[64:67], v[160:163]
    ds_read_b64_tr_b16 a[94:95], v227 offset:47104
    v_mfma_f32_16x16x32_bf16 v[176:179], a[64:67], v[68:71], v[176:179]
    ds_write_b64 v247, v[250:251] offset:6144
    v_mfma_f32_16x16x32_bf16 v[192:195], a[64:67], v[72:75], v[192:195]
    v_accvgpr_read_b32 v250, a56
    v_accvgpr_read_b32 v251, a57
    v_mfma_f32_16x16x32_bf16 v[208:211], a[64:67], v[76:79], v[208:211]
    s_waitcnt vmcnt(6)
    s_barrier
    ds_read_b64_tr_b16 a[64:65], v224 offset:49152
    v_mfma_f32_16x16x32_bf16 v[164:167], a[68:71], v[64:67], v[164:167]
    ds_read_b64_tr_b16 a[66:67], v224 offset:51200
    v_accvgpr_read_b32 v252, a58
    v_mfma_f32_16x16x32_bf16 v[180:183], a[68:71], v[68:71], v[180:183]
    v_accvgpr_read_b32 v253, a59
    v_mul_f32 v250, v245, v250
    v_mfma_f32_16x16x32_bf16 v[196:199], a[68:71], v[72:75], v[196:199]
    s_waitcnt lgkmcnt(12)
    v_mul_f32 v251, v245, v251
    v_mul_f32 v252, v245, v252
    v_mfma_f32_16x16x32_bf16 v[212:215], a[68:71], v[76:79], v[212:215]
    ds_read_b64_tr_b16 a[68:69], v225 offset:49152
    v_mul_f32 v253, v245, v253
    v_mfma_f32_16x16x32_bf16 v[168:171], a[72:75], v[64:67], v[168:171]
    ds_read_b64_tr_b16 a[70:71], v225 offset:51200
    v_cvt_pk_bf16_f32 v250, v250, v251
    v_mfma_f32_16x16x32_bf16 v[184:187], a[72:75], v[68:71], v[184:187]
    v_cvt_pk_bf16_f32 v251, v252, v253
    v_mfma_f32_16x16x32_bf16 v[200:203], a[72:75], v[72:75], v[200:203]
    ds_write_b64 v248, v[250:251] offset:6144
    v_accvgpr_read_b32 v250, a60
    v_accvgpr_read_b32 v251, a61
    v_accvgpr_read_b32 v252, a62
    v_accvgpr_read_b32 v253, a63
    v_mul_f32 v250, v245, v250
    v_mul_f32 v251, v245, v251
    v_mul_f32 v252, v245, v252
    v_mul_f32 v253, v245, v253
    v_cvt_pk_bf16_f32 v250, v250, v251
    v_cvt_pk_bf16_f32 v251, v252, v253
    ds_write_b64 v249, v[250:251] offset:6144
    ds_read_b128 a[48:51], v239 offset:6144
    ds_read_b128 a[52:55], v239 offset:7168
    v_mfma_f32_16x16x32_bf16 v[216:219], a[72:75], v[76:79], v[216:219]
    ds_read_b64_tr_b16 a[72:73], v226 offset:49152
    v_mfma_f32_16x16x32_bf16 v[172:175], a[76:79], v[64:67], v[172:175]
    ds_read_b64_tr_b16 a[74:75], v226 offset:51200
    v_mfma_f32_16x16x32_bf16 v[188:191], a[76:79], v[68:71], v[188:191]
    s_waitcnt lgkmcnt(3)
    v_mfma_f32_16x16x32_bf16 v[204:207], a[76:79], v[72:75], v[204:207]
    buffer_store_dwordx4 a[48:51], v240, s[24:27], s36 offen sc0 sc1 nt
    v_mfma_f32_16x16x32_bf16 v[220:223], a[76:79], v[76:79], v[220:223]
    ds_read_b64_tr_b16 a[76:77], v227 offset:49152
    v_mfma_f32_16x16x32_bf16 v[160:163], a[80:83], v[80:83], v[160:163]
    ds_read_b64_tr_b16 a[78:79], v227 offset:51200
    v_mfma_f32_16x16x32_bf16 v[176:179], a[80:83], v[84:87], v[176:179]
    s_waitcnt lgkmcnt(4)
    v_mfma_f32_16x16x32_bf16 v[192:195], a[80:83], v[88:91], v[192:195]
    buffer_store_dwordx4 a[52:55], v240, s[24:27], s36 offen offset:2048 sc0 sc1 nt
    v_mfma_f32_16x16x32_bf16 v[208:211], a[80:83], v[92:95], v[208:211]
    ds_read_b64_tr_b16 a[80:81], v224 offset:53248
    v_mfma_f32_16x16x32_bf16 v[164:167], a[84:87], v[80:83], v[164:167]
    ds_read_b64_tr_b16 a[82:83], v224 offset:55296
    v_mfma_f32_16x16x32_bf16 v[180:183], a[84:87], v[84:87], v[180:183]
    v_mfma_f32_16x16x32_bf16 v[196:199], a[84:87], v[88:91], v[196:199]
    v_mfma_f32_16x16x32_bf16 v[212:215], a[84:87], v[92:95], v[212:215]
    ds_read_b64_tr_b16 a[84:85], v225 offset:53248
    v_mfma_f32_16x16x32_bf16 v[168:171], a[88:91], v[80:83], v[168:171]
    ds_read_b64_tr_b16 a[86:87], v225 offset:55296
    v_mfma_f32_16x16x32_bf16 v[184:187], a[88:91], v[84:87], v[184:187]
    v_mfma_f32_16x16x32_bf16 v[200:203], a[88:91], v[88:91], v[200:203]
    v_mfma_f32_16x16x32_bf16 v[216:219], a[88:91], v[92:95], v[216:219]
    ds_read_b64_tr_b16 a[88:89], v226 offset:53248
    v_mfma_f32_16x16x32_bf16 v[172:175], a[92:95], v[80:83], v[172:175]
    ds_read_b64_tr_b16 a[90:91], v226 offset:55296
    v_mfma_f32_16x16x32_bf16 v[188:191], a[92:95], v[84:87], v[188:191]
    v_mfma_f32_16x16x32_bf16 v[204:207], a[92:95], v[88:91], v[204:207]
    v_mfma_f32_16x16x32_bf16 v[220:223], a[92:95], v[92:95], v[220:223]
    ds_read_b64_tr_b16 a[92:93], v227 offset:53248
    v_mfma_f32_16x16x32_bf16 v[160:163], a[64:67], v[96:99], v[160:163]
    ds_read_b64_tr_b16 a[94:95], v227 offset:55296
    v_mfma_f32_16x16x32_bf16 v[176:179], a[64:67], v[100:103], v[176:179]
    v_mfma_f32_16x16x32_bf16 v[192:195], a[64:67], v[104:107], v[192:195]
    v_mfma_f32_16x16x32_bf16 v[208:211], a[64:67], v[108:111], v[208:211]
    ds_read_b64_tr_b16 a[64:65], v224 offset:57344
    v_mfma_f32_16x16x32_bf16 v[164:167], a[68:71], v[96:99], v[164:167]
    ds_read_b64_tr_b16 a[66:67], v224 offset:59392
    v_mfma_f32_16x16x32_bf16 v[180:183], a[68:71], v[100:103], v[180:183]
    v_mfma_f32_16x16x32_bf16 v[196:199], a[68:71], v[104:107], v[196:199]
    s_waitcnt lgkmcnt(10)
    v_mfma_f32_16x16x32_bf16 v[212:215], a[68:71], v[108:111], v[212:215]
    ds_read_b64_tr_b16 a[68:69], v225 offset:57344
    v_mfma_f32_16x16x32_bf16 v[168:171], a[72:75], v[96:99], v[168:171]
    ds_read_b64_tr_b16 a[70:71], v225 offset:59392
    v_cmp_nge_f32 vcc, s41, v228
    v_mfma_f32_16x16x32_bf16 v[184:187], a[72:75], v[100:103], v[184:187]
    v_mfma_f32_16x16x32_bf16 v[200:203], a[72:75], v[104:107], v[200:203]
    v_mfma_f32_16x16x32_bf16 v[216:219], a[72:75], v[108:111], v[216:219]
    ds_read_b64_tr_b16 a[72:73], v226 offset:57344
    v_mfma_f32_16x16x32_bf16 v[172:175], a[76:79], v[96:99], v[172:175]
    ds_read_b64_tr_b16 a[74:75], v226 offset:59392
    v_mfma_f32_16x16x32_bf16 v[188:191], a[76:79], v[100:103], v[188:191]
    v_mfma_f32_16x16x32_bf16 v[204:207], a[76:79], v[104:107], v[204:207]
    s_waitcnt lgkmcnt(10)
    v_mfma_f32_16x16x32_bf16 v[220:223], a[76:79], v[108:111], v[220:223]
    ds_read_b64_tr_b16 a[76:77], v227 offset:57344
    v_mfma_f32_16x16x32_bf16 v[160:163], a[80:83], v[112:115], v[160:163]
    s_cbranch_vccnz L_slow
    v_mfma_f32_16x16x32_bf16 v[176:179], a[80:83], v[116:119], v[176:179]
    ds_read_b64_tr_b16 a[78:79], v227 offset:59392
    v_mfma_f32_16x16x32_bf16 v[192:195], a[80:83], v[120:123], v[192:195]
    v_mfma_f32_16x16x32_bf16 v[208:211], a[80:83], v[124:127], v[208:211]
    ds_read_b64_tr_b16 a[80:81], v224 offset:61440
    v_mfma_f32_16x16x32_bf16 v[164:167], a[84:87], v[112:115], v[164:167]
    ds_read_b64_tr_b16 a[82:83], v224 offset:63488
    v_mfma_f32_16x16x32_bf16 v[180:183], a[84:87], v[116:119], v[180:183]
    v_mfma_f32_16x16x32_bf16 v[196:199], a[84:87], v[120:123], v[196:199]
    s_waitcnt lgkmcnt(10)
    v_mfma_f32_16x16x32_bf16 v[212:215], a[84:87], v[124:127], v[212:215]
    ds_read_b64_tr_b16 a[84:85], v225 offset:61440
    v_mfma_f32_16x16x32_bf16 v[168:171], a[88:91], v[112:115], v[168:171]
    ds_read_b64_tr_b16 a[86:87], v225 offset:63488
    v_mfma_f32_16x16x32_bf16 v[184:187], a[88:91], v[116:119], v[184:187]
    v_mfma_f32_16x16x32_bf16 v[200:203], a[88:91], v[120:123], v[200:203]
    v_mfma_f32_16x16x32_bf16 v[216:219], a[88:91], v[124:127], v[216:219]
    ds_read_b64_tr_b16 a[88:89], v226 offset:61440
    v_mfma_f32_16x16x32_bf16 v[172:175], a[92:95], v[112:115], v[172:175]
    ds_read_b64_tr_b16 a[90:91], v226 offset:63488
    v_mfma_f32_16x16x32_bf16 v[188:191], a[92:95], v[116:119], v[188:191]
    v_mfma_f32_16x16x32_bf16 v[204:207], a[92:95], v[120:123], v[204:207]
    v_mfma_f32_16x16x32_bf16 v[220:223], a[92:95], v[124:127], v[220:223]
    s_waitcnt lgkmcnt(10)
    v_mfma_f32_16x16x32_bf16 v[160:163], a[64:67], v[128:131], v[160:163]
    ds_read_b64_tr_b16 a[92:93], v227 offset:61440
    v_mfma_f32_16x16x32_bf16 v[164:167], a[68:71], v[128:131], v[164:167]
    ds_read_b64_tr_b16 a[94:95], v227 offset:63488
    s_waitcnt lgkmcnt(8)
    v_mfma_f32_16x16x32_bf16 v[168:171], a[72:75], v[128:131], v[168:171]
    v_mfma_f32_16x16x32_bf16 v[172:175], a[76:79], v[128:131], v[172:175]
    s_waitcnt lgkmcnt(4)
    v_mfma_f32_16x16x32_bf16 v[160:163], a[80:83], v[144:147], v[160:163]
    v_mfma_f32_16x16x32_bf16 v[164:167], a[84:87], v[144:147], v[164:167]
    s_waitcnt lgkmcnt(0)
    v_mfma_f32_16x16x32_bf16 v[168:171], a[88:91], v[144:147], v[168:171]
    v_mfma_f32_16x16x32_bf16 v[172:175], a[92:95], v[144:147], v[172:175]
    v_mfma_f32_16x16x32_bf16 v[176:179], a[64:67], v[132:135], v[176:179]
    v_mfma_f32_16x16x32_bf16 v[180:183], a[68:71], v[132:135], v[180:183]
    v_mfma_f32_16x16x32_bf16 v[184:187], a[72:75], v[132:135], v[184:187]
    v_mfma_f32_16x16x32_bf16 v[188:191], a[76:79], v[132:135], v[188:191]
    v_mul_f32 v160, v242, v160
    v_mul_f32 v161, v242, v161
    v_mfma_f32_16x16x32_bf16 v[176:179], a[80:83], v[148:151], v[176:179]
    v_mul_f32 v162, v242, v162
    v_mul_f32 v163, v242, v163
    v_mfma_f32_16x16x32_bf16 v[180:183], a[84:87], v[148:151], v[180:183]
    v_cvt_pk_bf16_f32 v160, v160, v161
    v_cvt_pk_bf16_f32 v161, v162, v163
    v_mfma_f32_16x16x32_bf16 v[184:187], a[88:91], v[148:151], v[184:187]
    ds_write_b64 v246, v[160:161] offset:0
    v_mfma_f32_16x16x32_bf16 v[188:191], a[92:95], v[148:151], v[188:191]
    v_mul_f32 v164, v242, v164
    v_mul_f32 v165, v242, v165
    v_mfma_f32_16x16x32_bf16 v[192:195], a[64:67], v[136:139], v[192:195]
    v_mul_f32 v166, v242, v166
    v_mul_f32 v167, v242, v167
    v_mfma_f32_16x16x32_bf16 v[196:199], a[68:71], v[136:139], v[196:199]
    v_cvt_pk_bf16_f32 v164, v164, v165
    v_cvt_pk_bf16_f32 v165, v166, v167
    v_mfma_f32_16x16x32_bf16 v[200:203], a[72:75], v[136:139], v[200:203]
    ds_write_b64 v247, v[164:165] offset:0
    v_mfma_f32_16x16x32_bf16 v[204:207], a[76:79], v[136:139], v[204:207]
    v_mul_f32 v168, v242, v168
    v_mul_f32 v169, v242, v169
    v_mfma_f32_16x16x32_bf16 v[192:195], a[80:83], v[152:155], v[192:195]
    v_mul_f32 v170, v242, v170
    v_mul_f32 v171, v242, v171
    v_mfma_f32_16x16x32_bf16 v[196:199], a[84:87], v[152:155], v[196:199]
    v_cvt_pk_bf16_f32 v168, v168, v169
    v_cvt_pk_bf16_f32 v169, v170, v171
    v_mfma_f32_16x16x32_bf16 v[200:203], a[88:91], v[152:155], v[200:203]
    ds_write_b64 v248, v[168:169] offset:0
    v_mfma_f32_16x16x32_bf16 v[204:207], a[92:95], v[152:155], v[204:207]
    v_mul_f32 v172, v242, v172
    v_mul_f32 v173, v242, v173
    v_mfma_f32_16x16x32_bf16 v[208:211], a[64:67], v[140:143], v[208:211]
    v_mul_f32 v174, v242, v174
    v_mul_f32 v175, v242, v175
    v_mfma_f32_16x16x32_bf16 v[212:215], a[68:71], v[140:143], v[212:215]
    v_cvt_pk_bf16_f32 v172, v172, v173
    v_cvt_pk_bf16_f32 v173, v174, v175
    v_mfma_f32_16x16x32_bf16 v[216:219], a[72:75], v[140:143], v[216:219]
    ds_write_b64 v249, v[172:173] offset:0
    v_mfma_f32_16x16x32_bf16 v[220:223], a[76:79], v[140:143], v[220:223]
    ds_read_b128 a[0:3], v239 offset:0
    v_mfma_f32_16x16x32_bf16 v[208:211], a[80:83], v[156:159], v[208:211]
    ds_read_b128 a[4:7], v239 offset:1024
    v_mfma_f32_16x16x32_bf16 v[212:215], a[84:87], v[156:159], v[212:215]
    v_mfma_f32_16x16x32_bf16 v[216:219], a[88:91], v[156:159], v[216:219]
    v_mfma_f32_16x16x32_bf16 v[220:223], a[92:95], v[156:159], v[220:223]
    v_pk_mul_f32 v[176:177], v[176:177], v[242:243] op_sel:[0,1] op_sel_hi:[1,1]
    v_pk_mul_f32 v[178:179], v[178:179], v[242:243] op_sel:[0,1] op_sel_hi:[1,1]
    v_cvt_pk_bf16_f32 v176, v176, v177
    v_cvt_pk_bf16_f32 v177, v178, v179
    ds_write_b64 v246, v[176:177] offset:2048
    v_pk_mul_f32 v[180:181], v[180:181], v[242:243] op_sel:[0,1] op_sel_hi:[1,1]
    v_pk_mul_f32 v[182:183], v[182:183], v[242:243] op_sel:[0,1] op_sel_hi:[1,1]
    s_waitcnt lgkmcnt(2)
    buffer_store_dwordx4 a[0:3], v240, s[24:27], s31 offen offset:128 sc0 sc1 nt
    v_cvt_pk_bf16_f32 v180, v180, v181
    v_cvt_pk_bf16_f32 v181, v182, v183
    ds_write_b64 v247, v[180:181] offset:2048
    v_pk_mul_f32 v[184:185], v[184:185], v[242:243] op_sel:[0,1] op_sel_hi:[1,1]
    v_pk_mul_f32 v[186:187], v[186:187], v[242:243] op_sel:[0,1] op_sel_hi:[1,1]
    v_cvt_pk_bf16_f32 v184, v184, v185
    v_cvt_pk_bf16_f32 v185, v186, v187
    s_waitcnt lgkmcnt(2)
    buffer_store_dwordx4 a[4:7], v240, s[24:27], s31 offen offset:2176 sc0 sc1 nt
    ds_write_b64 v248, v[184:185] offset:2048
    v_pk_mul_f32 v[188:189], v[188:189], v[242:243] op_sel:[0,1] op_sel_hi:[1,1]
    v_pk_mul_f32 v[190:191], v[190:191], v[242:243] op_sel:[0,1] op_sel_hi:[1,1]
    v_cvt_pk_bf16_f32 v188, v188, v189
    v_cvt_pk_bf16_f32 v189, v190, v191
    ds_write_b64 v249, v[188:189] offset:2048
    ds_read_b128 a[8:11], v239 offset:2048
    ds_read_b128 a[12:15], v239 offset:3072
    v_pk_mul_f32 v[192:193], v[192:193], v[244:245] op_sel:[0,0] op_sel_hi:[1,0]
    v_pk_mul_f32 v[194:195], v[194:195], v[244:245] op_sel:[0,0] op_sel_hi:[1,0]
    v_cvt_pk_bf16_f32 v192, v192, v193
    v_cvt_pk_bf16_f32 v193, v194, v195
    ds_write_b64 v246, v[192:193] offset:4096
    v_pk_mul_f32 v[196:197], v[196:197], v[244:245] op_sel:[0,0] op_sel_hi:[1,0]
    v_pk_mul_f32 v[198:199], v[198:199], v[244:245] op_sel:[0,0] op_sel_hi:[1,0]
    s_waitcnt lgkmcnt(2)
    buffer_store_dwordx4 a[8:11], v240, s[24:27], s34 offen offset:128 sc0 sc1 nt
    v_cvt_pk_bf16_f32 v196, v196, v197
    v_cvt_pk_bf16_f32 v197, v198, v199
    ds_write_b64 v247, v[196:197] offset:4096
    v_pk_mul_f32 v[200:201], v[200:201], v[244:245] op_sel:[0,0] op_sel_hi:[1,0]
    v_pk_mul_f32 v[202:203], v[202:203], v[244:245] op_sel:[0,0] op_sel_hi:[1,0]
    v_cvt_pk_bf16_f32 v200, v200, v201
    v_cvt_pk_bf16_f32 v201, v202, v203
    s_waitcnt lgkmcnt(2)
    buffer_store_dwordx4 a[12:15], v240, s[24:27], s34 offen offset:2176 sc0 sc1 nt
    ds_write_b64 v248, v[200:201] offset:4096
    v_pk_mul_f32 v[204:205], v[204:205], v[244:245] op_sel:[0,0] op_sel_hi:[1,0]
    v_pk_mul_f32 v[206:207], v[206:207], v[244:245] op_sel:[0,0] op_sel_hi:[1,0]
    v_cvt_pk_bf16_f32 v204, v204, v205
    v_cvt_pk_bf16_f32 v205, v206, v207
    ds_write_b64 v249, v[204:205] offset:4096
    ds_read_b128 a[16:19], v239 offset:4096
    ds_read_b128 a[20:23], v239 offset:5120
    v_pk_mul_f32 v[208:209], v[208:209], v[244:245] op_sel:[0,1] op_sel_hi:[1,1]
    v_pk_mul_f32 v[210:211], v[210:211], v[244:245] op_sel:[0,1] op_sel_hi:[1,1]
    v_cvt_pk_bf16_f32 v208, v208, v209
    v_cvt_pk_bf16_f32 v209, v210, v211
    ds_write_b64 v246, v[208:209] offset:6144
    v_pk_mul_f32 v[212:213], v[212:213], v[244:245] op_sel:[0,1] op_sel_hi:[1,1]
    v_pk_mul_f32 v[214:215], v[214:215], v[244:245] op_sel:[0,1] op_sel_hi:[1,1]
    s_waitcnt lgkmcnt(2)
    buffer_store_dwordx4 a[16:19], v240, s[24:27], s35 offen offset:128 sc0 sc1 nt
    v_cvt_pk_bf16_f32 v212, v212, v213
    v_cvt_pk_bf16_f32 v213, v214, v215
    ds_write_b64 v247, v[212:213] offset:6144
    v_pk_mul_f32 v[216:217], v[216:217], v[244:245] op_sel:[0,1] op_sel_hi:[1,1]
    v_pk_mul_f32 v[218:219], v[218:219], v[244:245] op_sel:[0,1] op_sel_hi:[1,1]
    v_cvt_pk_bf16_f32 v216, v216, v217
    v_cvt_pk_bf16_f32 v217, v218, v219
    s_waitcnt lgkmcnt(2)
    buffer_store_dwordx4 a[20:23], v240, s[24:27], s35 offen offset:2176 sc0 sc1 nt
    ds_write_b64 v248, v[216:217] offset:6144
    v_pk_mul_f32 v[220:221], v[220:221], v[244:245] op_sel:[0,1] op_sel_hi:[1,1]
    v_pk_mul_f32 v[222:223], v[222:223], v[244:245] op_sel:[0,1] op_sel_hi:[1,1]
    v_cvt_pk_bf16_f32 v220, v220, v221
    v_cvt_pk_bf16_f32 v221, v222, v223
    ds_write_b64 v249, v[220:221] offset:6144
    ds_read_b128 a[24:27], v239 offset:6144
    ds_read_b128 a[28:31], v239 offset:7168
    s_waitcnt lgkmcnt(1)
    buffer_store_dwordx4 a[24:27], v240, s[24:27], s36 offen offset:128 sc0 sc1 nt
    s_waitcnt lgkmcnt(0)
    buffer_store_dwordx4 a[28:31], v240, s[24:27], s36 offen offset:2176 sc0 sc1 nt
L_done:
L_end:
    s_endpgm
L_slow:
    s_waitcnt vmcnt(0) lgkmcnt(0)
    s_nop 7
    v_lshrrev_b32 v239, 2, v232
    v_bfe_u32 v238, v232, 3, 2
    v_lshlrev_b32 v238, 5, v238
    v_lshl_or_b32 v239, v239, 7, v238
    v_bfe_u32 v238, v232, 1, 1
    v_lshl_or_b32 v239, v238, 4, v239
    v_and_b32 v238, 1, v232
    v_lshl_or_b32 v151, v238, 3, v239
    v_mov_b32 v144, v151
    v_xor_b32 v145, 32, v151
    v_xor_b32 v146, 64, v151
    v_xor_b32 v147, 96, v151
    v_add_u32 v148, 0x10000, v144
    v_add_u32 v149, 0x10000, v145
    v_add_u32 v150, 0x10000, v146
    v_add_u32 v151, 0x10000, v147
    v_mov_b32 v192, v234
    v_mov_b32 v193, v234
    v_mov_b32 v194, v234
    v_mov_b32 v195, v234
    v_mov_b32 v196, v235
    v_mov_b32 v197, v235
    v_mov_b32 v198, v235
    v_mov_b32 v199, v235
    v_mov_b32 v200, v236
    v_mov_b32 v201, v236
    v_mov_b32 v202, v236
    v_mov_b32 v203, v236
    v_mov_b32 v204, v237
    v_mov_b32 v205, v237
    v_mov_b32 v206, v237
    v_mov_b32 v207, v237
    v_accvgpr_write_b32 a192, 0
    v_accvgpr_write_b32 a193, 0
    v_accvgpr_write_b32 a194, 0
    v_accvgpr_write_b32 a195, 0
    v_accvgpr_write_b32 a196, 0
    v_accvgpr_write_b32 a197, 0
    v_accvgpr_write_b32 a198, 0
    v_accvgpr_write_b32 a199, 0
    v_accvgpr_write_b32 a200, 0
    v_accvgpr_write_b32 a201, 0
    v_accvgpr_write_b32 a202, 0
    v_accvgpr_write_b32 a203, 0
    v_accvgpr_write_b32 a204, 0
    v_accvgpr_write_b32 a205, 0
    v_accvgpr_write_b32 a206, 0
    v_accvgpr_write_b32 a207, 0
    v_lshrrev_b32 v238, 4, v232
    v_and_b32 v239, 15, v232
    v_xor_b32 v240, v239, v238
    v_lshlrev_b32 v240, 4, v240
    v_lshl_or_b32 v152, v238, 8, v240
    v_xor_b32 v153, 64, v152
    v_xor_b32 v154, 128, v152
    v_xor_b32 v155, 192, v152
    v_lshl_or_b32 v240, v239, 8, v240
    v_add_u32 v224, s43, v240
    v_xor_b32 v225, 64, v224
    v_xor_b32 v226, 128, v224
    v_xor_b32 v227, 192, v224
    s_add_u32 m0, s43, 0
    s_add_u32 s39, s31, 0
    buffer_load_dwordx4 v152, s[12:15], s39 offen lds
    buffer_load_dwordx4 v153, s[12:15], s39 offen offset:1024 lds
    buffer_load_dwordx4 v154, s[12:15], s39 offen offset:2048 lds
    buffer_load_dwordx4 v155, s[12:15], s39 offen offset:3072 lds
    s_waitcnt vmcnt(0)
    ds_read_b128 v[0:3], v224
    ds_read_b128 v[4:7], v225
    ds_read_b128 v[8:11], v226
    ds_read_b128 v[12:15], v227
    s_waitcnt lgkmcnt(0)
    v_lshlrev_b32 v16, 16, v0
    v_and_b32 v17, 0xffff0000, v0
    v_pk_mul_f32 v[16:17], v[16:17], s[32:33]
    v_cvt_pk_bf16_f32 v16, v16, v17
    v_accvgpr_write_b32 a0, v16
    v_lshlrev_b32 v18, 16, v1
    v_and_b32 v19, 0xffff0000, v1
    v_pk_mul_f32 v[18:19], v[18:19], s[32:33]
    v_cvt_pk_bf16_f32 v18, v18, v19
    v_accvgpr_write_b32 a1, v18
    v_lshlrev_b32 v20, 16, v2
    v_and_b32 v21, 0xffff0000, v2
    v_pk_mul_f32 v[20:21], v[20:21], s[32:33]
    v_cvt_pk_bf16_f32 v20, v20, v21
    v_accvgpr_write_b32 a2, v20
    v_lshlrev_b32 v22, 16, v3
    v_and_b32 v23, 0xffff0000, v3
    v_pk_mul_f32 v[22:23], v[22:23], s[32:33]
    v_cvt_pk_bf16_f32 v22, v22, v23
    v_accvgpr_write_b32 a3, v22
    v_lshlrev_b32 v16, 16, v4
    v_and_b32 v17, 0xffff0000, v4
    v_pk_mul_f32 v[16:17], v[16:17], s[32:33]
    v_cvt_pk_bf16_f32 v16, v16, v17
    v_accvgpr_write_b32 a4, v16
    v_lshlrev_b32 v18, 16, v5
    v_and_b32 v19, 0xffff0000, v5
    v_pk_mul_f32 v[18:19], v[18:19], s[32:33]
    v_cvt_pk_bf16_f32 v18, v18, v19
    v_accvgpr_write_b32 a5, v18
    v_lshlrev_b32 v20, 16, v6
    v_and_b32 v21, 0xffff0000, v6
    v_pk_mul_f32 v[20:21], v[20:21], s[32:33]
    v_cvt_pk_bf16_f32 v20, v20, v21
    v_accvgpr_write_b32 a6, v20
    v_lshlrev_b32 v22, 16, v7
    v_and_b32 v23, 0xffff0000, v7
    v_pk_mul_f32 v[22:23], v[22:23], s[32:33]
    v_cvt_pk_bf16_f32 v22, v22, v23
    v_accvgpr_write_b32 a7, v22
    v_lshlrev_b32 v16, 16, v8
    v_and_b32 v17, 0xffff0000, v8
    v_pk_mul_f32 v[16:17], v[16:17], s[32:33]
    v_cvt_pk_bf16_f32 v16, v16, v17
    v_accvgpr_write_b32 a8, v16
    v_lshlrev_b32 v18, 16, v9
    v_and_b32 v19, 0xffff0000, v9
    v_pk_mul_f32 v[18:19], v[18:19], s[32:33]
    v_cvt_pk_bf16_f32 v18, v18, v19
    v_accvgpr_write_b32 a9, v18
    v_lshlrev_b32 v20, 16, v10
    v_and_b32 v21, 0xffff0000, v10
    v_pk_mul_f32 v[20:21], v[20:21], s[32:33]
    v_cvt_pk_bf16_f32 v20, v20, v21
    v_accvgpr_write_b32 a10, v20
    v_lshlrev_b32 v22, 16, v11
    v_and_b32 v23, 0xffff0000, v11
    v_pk_mul_f32 v[22:23], v[22:23], s[32:33]
    v_cvt_pk_bf16_f32 v22, v22, v23
    v_accvgpr_write_b32 a11, v22
    v_lshlrev_b32 v16, 16, v12
    v_and_b32 v17, 0xffff0000, v12
    v_pk_mul_f32 v[16:17], v[16:17], s[32:33]
    v_cvt_pk_bf16_f32 v16, v16, v17
    v_accvgpr_write_b32 a12, v16
    v_lshlrev_b32 v18, 16, v13
    v_and_b32 v19, 0xffff0000, v13
    v_pk_mul_f32 v[18:19], v[18:19], s[32:33]
    v_cvt_pk_bf16_f32 v18, v18, v19
    v_accvgpr_write_b32 a13, v18
    v_lshlrev_b32 v20, 16, v14
    v_and_b32 v21, 0xffff0000, v14
    v_pk_mul_f32 v[20:21], v[20:21], s[32:33]
    v_cvt_pk_bf16_f32 v20, v20, v21
    v_accvgpr_write_b32 a14, v20
    v_lshlrev_b32 v22, 16, v15
    v_and_b32 v23, 0xffff0000, v15
    v_pk_mul_f32 v[22:23], v[22:23], s[32:33]
    v_cvt_pk_bf16_f32 v22, v22, v23
    v_accvgpr_write_b32 a15, v22
    s_add_u32 m0, s43, 0
    s_add_u32 s39, s34, 0
    buffer_load_dwordx4 v152, s[12:15], s39 offen lds
    buffer_load_dwordx4 v153, s[12:15], s39 offen offset:1024 lds
    buffer_load_dwordx4 v154, s[12:15], s39 offen offset:2048 lds
    buffer_load_dwordx4 v155, s[12:15], s39 offen offset:3072 lds
    s_waitcnt vmcnt(0)
    ds_read_b128 v[0:3], v224
    ds_read_b128 v[4:7], v225
    ds_read_b128 v[8:11], v226
    ds_read_b128 v[12:15], v227
    s_waitcnt lgkmcnt(0)
    v_lshlrev_b32 v16, 16, v0
    v_and_b32 v17, 0xffff0000, v0
    v_pk_mul_f32 v[16:17], v[16:17], s[32:33]
    v_cvt_pk_bf16_f32 v16, v16, v17
    v_accvgpr_write_b32 a16, v16
    v_lshlrev_b32 v18, 16, v1
    v_and_b32 v19, 0xffff0000, v1
    v_pk_mul_f32 v[18:19], v[18:19], s[32:33]
    v_cvt_pk_bf16_f32 v18, v18, v19
    v_accvgpr_write_b32 a17, v18
    v_lshlrev_b32 v20, 16, v2
    v_and_b32 v21, 0xffff0000, v2
    v_pk_mul_f32 v[20:21], v[20:21], s[32:33]
    v_cvt_pk_bf16_f32 v20, v20, v21
    v_accvgpr_write_b32 a18, v20
    v_lshlrev_b32 v22, 16, v3
    v_and_b32 v23, 0xffff0000, v3
    v_pk_mul_f32 v[22:23], v[22:23], s[32:33]
    v_cvt_pk_bf16_f32 v22, v22, v23
    v_accvgpr_write_b32 a19, v22
    v_lshlrev_b32 v16, 16, v4
    v_and_b32 v17, 0xffff0000, v4
    v_pk_mul_f32 v[16:17], v[16:17], s[32:33]
    v_cvt_pk_bf16_f32 v16, v16, v17
    v_accvgpr_write_b32 a20, v16
    v_lshlrev_b32 v18, 16, v5
    v_and_b32 v19, 0xffff0000, v5
    v_pk_mul_f32 v[18:19], v[18:19], s[32:33]
    v_cvt_pk_bf16_f32 v18, v18, v19
    v_accvgpr_write_b32 a21, v18
    v_lshlrev_b32 v20, 16, v6
    v_and_b32 v21, 0xffff0000, v6
    v_pk_mul_f32 v[20:21], v[20:21], s[32:33]
    v_cvt_pk_bf16_f32 v20, v20, v21
    v_accvgpr_write_b32 a22, v20
    v_lshlrev_b32 v22, 16, v7
    v_and_b32 v23, 0xffff0000, v7
    v_pk_mul_f32 v[22:23], v[22:23], s[32:33]
    v_cvt_pk_bf16_f32 v22, v22, v23
    v_accvgpr_write_b32 a23, v22
    v_lshlrev_b32 v16, 16, v8
    v_and_b32 v17, 0xffff0000, v8
    v_pk_mul_f32 v[16:17], v[16:17], s[32:33]
    v_cvt_pk_bf16_f32 v16, v16, v17
    v_accvgpr_write_b32 a24, v16
    v_lshlrev_b32 v18, 16, v9
    v_and_b32 v19, 0xffff0000, v9
    v_pk_mul_f32 v[18:19], v[18:19], s[32:33]
    v_cvt_pk_bf16_f32 v18, v18, v19
    v_accvgpr_write_b32 a25, v18
    v_lshlrev_b32 v20, 16, v10
    v_and_b32 v21, 0xffff0000, v10
    v_pk_mul_f32 v[20:21], v[20:21], s[32:33]
    v_cvt_pk_bf16_f32 v20, v20, v21
    v_accvgpr_write_b32 a26, v20
    v_lshlrev_b32 v22, 16, v11
    v_and_b32 v23, 0xffff0000, v11
    v_pk_mul_f32 v[22:23], v[22:23], s[32:33]
    v_cvt_pk_bf16_f32 v22, v22, v23
    v_accvgpr_write_b32 a27, v22
    v_lshlrev_b32 v16, 16, v12
    v_and_b32 v17, 0xffff0000, v12
    v_pk_mul_f32 v[16:17], v[16:17], s[32:33]
    v_cvt_pk_bf16_f32 v16, v16, v17
    v_accvgpr_write_b32 a28, v16
    v_lshlrev_b32 v18, 16, v13
    v_and_b32 v19, 0xffff0000, v13
    v_pk_mul_f32 v[18:19], v[18:19], s[32:33]
    v_cvt_pk_bf16_f32 v18, v18, v19
    v_accvgpr_write_b32 a29, v18
    v_lshlrev_b32 v20, 16, v14
    v_and_b32 v21, 0xffff0000, v14
    v_pk_mul_f32 v[20:21], v[20:21], s[32:33]
    v_cvt_pk_bf16_f32 v20, v20, v21
    v_accvgpr_write_b32 a30, v20
    v_lshlrev_b32 v22, 16, v15
    v_and_b32 v23, 0xffff0000, v15
    v_pk_mul_f32 v[22:23], v[22:23], s[32:33]
    v_cvt_pk_bf16_f32 v22, v22, v23
    v_accvgpr_write_b32 a31, v22
    s_add_u32 m0, s43, 0
    s_add_u32 s39, s35, 0
    buffer_load_dwordx4 v152, s[12:15], s39 offen lds
    buffer_load_dwordx4 v153, s[12:15], s39 offen offset:1024 lds
    buffer_load_dwordx4 v154, s[12:15], s39 offen offset:2048 lds
    buffer_load_dwordx4 v155, s[12:15], s39 offen offset:3072 lds
    s_waitcnt vmcnt(0)
    ds_read_b128 v[0:3], v224
    ds_read_b128 v[4:7], v225
    ds_read_b128 v[8:11], v226
    ds_read_b128 v[12:15], v227
    s_waitcnt lgkmcnt(0)
    v_lshlrev_b32 v16, 16, v0
    v_and_b32 v17, 0xffff0000, v0
    v_pk_mul_f32 v[16:17], v[16:17], s[32:33]
    v_cvt_pk_bf16_f32 v16, v16, v17
    v_accvgpr_write_b32 a32, v16
    v_lshlrev_b32 v18, 16, v1
    v_and_b32 v19, 0xffff0000, v1
    v_pk_mul_f32 v[18:19], v[18:19], s[32:33]
    v_cvt_pk_bf16_f32 v18, v18, v19
    v_accvgpr_write_b32 a33, v18
    v_lshlrev_b32 v20, 16, v2
    v_and_b32 v21, 0xffff0000, v2
    v_pk_mul_f32 v[20:21], v[20:21], s[32:33]
    v_cvt_pk_bf16_f32 v20, v20, v21
    v_accvgpr_write_b32 a34, v20
    v_lshlrev_b32 v22, 16, v3
    v_and_b32 v23, 0xffff0000, v3
    v_pk_mul_f32 v[22:23], v[22:23], s[32:33]
    v_cvt_pk_bf16_f32 v22, v22, v23
    v_accvgpr_write_b32 a35, v22
    v_lshlrev_b32 v16, 16, v4
    v_and_b32 v17, 0xffff0000, v4
    v_pk_mul_f32 v[16:17], v[16:17], s[32:33]
    v_cvt_pk_bf16_f32 v16, v16, v17
    v_accvgpr_write_b32 a36, v16
    v_lshlrev_b32 v18, 16, v5
    v_and_b32 v19, 0xffff0000, v5
    v_pk_mul_f32 v[18:19], v[18:19], s[32:33]
    v_cvt_pk_bf16_f32 v18, v18, v19
    v_accvgpr_write_b32 a37, v18
    v_lshlrev_b32 v20, 16, v6
    v_and_b32 v21, 0xffff0000, v6
    v_pk_mul_f32 v[20:21], v[20:21], s[32:33]
    v_cvt_pk_bf16_f32 v20, v20, v21
    v_accvgpr_write_b32 a38, v20
    v_lshlrev_b32 v22, 16, v7
    v_and_b32 v23, 0xffff0000, v7
    v_pk_mul_f32 v[22:23], v[22:23], s[32:33]
    v_cvt_pk_bf16_f32 v22, v22, v23
    v_accvgpr_write_b32 a39, v22
    v_lshlrev_b32 v16, 16, v8
    v_and_b32 v17, 0xffff0000, v8
    v_pk_mul_f32 v[16:17], v[16:17], s[32:33]
    v_cvt_pk_bf16_f32 v16, v16, v17
    v_accvgpr_write_b32 a40, v16
    v_lshlrev_b32 v18, 16, v9
    v_and_b32 v19, 0xffff0000, v9
    v_pk_mul_f32 v[18:19], v[18:19], s[32:33]
    v_cvt_pk_bf16_f32 v18, v18, v19
    v_accvgpr_write_b32 a41, v18
    v_lshlrev_b32 v20, 16, v10
    v_and_b32 v21, 0xffff0000, v10
    v_pk_mul_f32 v[20:21], v[20:21], s[32:33]
    v_cvt_pk_bf16_f32 v20, v20, v21
    v_accvgpr_write_b32 a42, v20
    v_lshlrev_b32 v22, 16, v11
    v_and_b32 v23, 0xffff0000, v11
    v_pk_mul_f32 v[22:23], v[22:23], s[32:33]
    v_cvt_pk_bf16_f32 v22, v22, v23
    v_accvgpr_write_b32 a43, v22
    v_lshlrev_b32 v16, 16, v12
    v_and_b32 v17, 0xffff0000, v12
    v_pk_mul_f32 v[16:17], v[16:17], s[32:33]
    v_cvt_pk_bf16_f32 v16, v16, v17
    v_accvgpr_write_b32 a44, v16
    v_lshlrev_b32 v18, 16, v13
    v_and_b32 v19, 0xffff0000, v13
    v_pk_mul_f32 v[18:19], v[18:19], s[32:33]
    v_cvt_pk_bf16_f32 v18, v18, v19
    v_accvgpr_write_b32 a45, v18
    v_lshlrev_b32 v20, 16, v14
    v_and_b32 v21, 0xffff0000, v14
    v_pk_mul_f32 v[20:21], v[20:21], s[32:33]
    v_cvt_pk_bf16_f32 v20, v20, v21
    v_accvgpr_write_b32 a46, v20
    v_lshlrev_b32 v22, 16, v15
    v_and_b32 v23, 0xffff0000, v15
    v_pk_mul_f32 v[22:23], v[22:23], s[32:33]
    v_cvt_pk_bf16_f32 v22, v22, v23
    v_accvgpr_write_b32 a47, v22
    s_add_u32 m0, s43, 0
    s_add_u32 s39, s36, 0
    buffer_load_dwordx4 v152, s[12:15], s39 offen lds
    buffer_load_dwordx4 v153, s[12:15], s39 offen offset:1024 lds
    buffer_load_dwordx4 v154, s[12:15], s39 offen offset:2048 lds
    buffer_load_dwordx4 v155, s[12:15], s39 offen offset:3072 lds
    s_waitcnt vmcnt(0)
    ds_read_b128 v[0:3], v224
    ds_read_b128 v[4:7], v225
    ds_read_b128 v[8:11], v226
    ds_read_b128 v[12:15], v227
    s_waitcnt lgkmcnt(0)
    v_lshlrev_b32 v16, 16, v0
    v_and_b32 v17, 0xffff0000, v0
    v_pk_mul_f32 v[16:17], v[16:17], s[32:33]
    v_cvt_pk_bf16_f32 v16, v16, v17
    v_accvgpr_write_b32 a48, v16
    v_lshlrev_b32 v18, 16, v1
    v_and_b32 v19, 0xffff0000, v1
    v_pk_mul_f32 v[18:19], v[18:19], s[32:33]
    v_cvt_pk_bf16_f32 v18, v18, v19
    v_accvgpr_write_b32 a49, v18
    v_lshlrev_b32 v20, 16, v2
    v_and_b32 v21, 0xffff0000, v2
    v_pk_mul_f32 v[20:21], v[20:21], s[32:33]
    v_cvt_pk_bf16_f32 v20, v20, v21
    v_accvgpr_write_b32 a50, v20
    v_lshlrev_b32 v22, 16, v3
    v_and_b32 v23, 0xffff0000, v3
    v_pk_mul_f32 v[22:23], v[22:23], s[32:33]
    v_cvt_pk_bf16_f32 v22, v22, v23
    v_accvgpr_write_b32 a51, v22
    v_lshlrev_b32 v16, 16, v4
    v_and_b32 v17, 0xffff0000, v4
    v_pk_mul_f32 v[16:17], v[16:17], s[32:33]
    v_cvt_pk_bf16_f32 v16, v16, v17
    v_accvgpr_write_b32 a52, v16
    v_lshlrev_b32 v18, 16, v5
    v_and_b32 v19, 0xffff0000, v5
    v_pk_mul_f32 v[18:19], v[18:19], s[32:33]
    v_cvt_pk_bf16_f32 v18, v18, v19
    v_accvgpr_write_b32 a53, v18
    v_lshlrev_b32 v20, 16, v6
    v_and_b32 v21, 0xffff0000, v6
    v_pk_mul_f32 v[20:21], v[20:21], s[32:33]
    v_cvt_pk_bf16_f32 v20, v20, v21
    v_accvgpr_write_b32 a54, v20
    v_lshlrev_b32 v22, 16, v7
    v_and_b32 v23, 0xffff0000, v7
    v_pk_mul_f32 v[22:23], v[22:23], s[32:33]
    v_cvt_pk_bf16_f32 v22, v22, v23
    v_accvgpr_write_b32 a55, v22
    v_lshlrev_b32 v16, 16, v8
    v_and_b32 v17, 0xffff0000, v8
    v_pk_mul_f32 v[16:17], v[16:17], s[32:33]
    v_cvt_pk_bf16_f32 v16, v16, v17
    v_accvgpr_write_b32 a56, v16
    v_lshlrev_b32 v18, 16, v9
    v_and_b32 v19, 0xffff0000, v9
    v_pk_mul_f32 v[18:19], v[18:19], s[32:33]
    v_cvt_pk_bf16_f32 v18, v18, v19
    v_accvgpr_write_b32 a57, v18
    v_lshlrev_b32 v20, 16, v10
    v_and_b32 v21, 0xffff0000, v10
    v_pk_mul_f32 v[20:21], v[20:21], s[32:33]
    v_cvt_pk_bf16_f32 v20, v20, v21
    v_accvgpr_write_b32 a58, v20
    v_lshlrev_b32 v22, 16, v11
    v_and_b32 v23, 0xffff0000, v11
    v_pk_mul_f32 v[22:23], v[22:23], s[32:33]
    v_cvt_pk_bf16_f32 v22, v22, v23
    v_accvgpr_write_b32 a59, v22
    v_lshlrev_b32 v16, 16, v12
    v_and_b32 v17, 0xffff0000, v12
    v_pk_mul_f32 v[16:17], v[16:17], s[32:33]
    v_cvt_pk_bf16_f32 v16, v16, v17
    v_accvgpr_write_b32 a60, v16
    v_lshlrev_b32 v18, 16, v13
    v_and_b32 v19, 0xffff0000, v13
    v_pk_mul_f32 v[18:19], v[18:19], s[32:33]
    v_cvt_pk_bf16_f32 v18, v18, v19
    v_accvgpr_write_b32 a61, v18
    v_lshlrev_b32 v20, 16, v14
    v_and_b32 v21, 0xffff0000, v14
    v_pk_mul_f32 v[20:21], v[20:21], s[32:33]
    v_cvt_pk_bf16_f32 v20, v20, v21
    v_accvgpr_write_b32 a62, v20
    v_lshlrev_b32 v22, 16, v15
    v_and_b32 v23, 0xffff0000, v15
    v_pk_mul_f32 v[22:23], v[22:23], s[32:33]
    v_cvt_pk_bf16_f32 v22, v22, v23
    v_accvgpr_write_b32 a63, v22
    v_mov_b32 v0, 0
    v_mov_b32 v1, 0
    v_mov_b32 v2, 0
    v_mov_b32 v3, 0
    v_mov_b32 v4, 0
    v_mov_b32 v5, 0
    v_mov_b32 v6, 0
    v_mov_b32 v7, 0
    v_mov_b32 v8, 0
    v_mov_b32 v9, 0
    v_mov_b32 v10, 0
    v_mov_b32 v11, 0
    v_mov_b32 v12, 0
    v_mov_b32 v13, 0
    v_mov_b32 v14, 0
    v_mov_b32 v15, 0
    v_mov_b32 v16, 0
    v_mov_b32 v17, 0
    v_mov_b32 v18, 0
    v_mov_b32 v19, 0
    v_mov_b32 v20, 0
    v_mov_b32 v21, 0
    v_mov_b32 v22, 0
    v_mov_b32 v23, 0
    v_mov_b32 v24, 0
    v_mov_b32 v25, 0
    v_mov_b32 v26, 0
    v_mov_b32 v27, 0
    v_mov_b32 v28, 0
    v_mov_b32 v29, 0
    v_mov_b32 v30, 0
    v_mov_b32 v31, 0
    v_mov_b32 v32, 0
    v_mov_b32 v33, 0
    v_mov_b32 v34, 0
    v_mov_b32 v35, 0
    v_mov_b32 v36, 0
    v_mov_b32 v37, 0
    v_mov_b32 v38, 0
    v_mov_b32 v39, 0
    v_mov_b32 v40, 0
    v_mov_b32 v41, 0
    v_mov_b32 v42, 0
    v_mov_b32 v43, 0
    v_mov_b32 v44, 0
    v_mov_b32 v45, 0
    v_mov_b32 v46, 0
    v_mov_b32 v47, 0
    v_mov_b32 v48, 0
    v_mov_b32 v49, 0
    v_mov_b32 v50, 0
    v_mov_b32 v51, 0
    v_mov_b32 v52, 0
    v_mov_b32 v53, 0
    v_mov_b32 v54, 0
    v_mov_b32 v55, 0
    v_mov_b32 v56, 0
    v_mov_b32 v57, 0
    v_mov_b32 v58, 0
    v_mov_b32 v59, 0
    v_mov_b32 v60, 0
    v_mov_b32 v61, 0
    v_mov_b32 v62, 0
    v_mov_b32 v63, 0
    v_mov_b32 v64, 0
    v_mov_b32 v65, 0
    v_mov_b32 v66, 0
    v_mov_b32 v67, 0
    v_mov_b32 v68, 0
    v_mov_b32 v69, 0
    v_mov_b32 v70, 0
    v_mov_b32 v71, 0
    v_mov_b32 v72, 0
    v_mov_b32 v73, 0
    v_mov_b32 v74, 0
    v_mov_b32 v75, 0
    v_mov_b32 v76, 0
    v_mov_b32 v77, 0
    v_mov_b32 v78, 0
    v_mov_b32 v79, 0
    v_mov_b32 v80, 0
    v_mov_b32 v81, 0
    v_mov_b32 v82, 0
    v_mov_b32 v83, 0
    v_mov_b32 v84, 0
    v_mov_b32 v85, 0
    v_mov_b32 v86, 0
    v_mov_b32 v87, 0
    v_mov_b32 v88, 0
    v_mov_b32 v89, 0
    v_mov_b32 v90, 0
    v_mov_b32 v91, 0
    v_mov_b32 v92, 0
    v_mov_b32 v93, 0
    v_mov_b32 v94, 0
    v_mov_b32 v95, 0
    v_mov_b32 v96, 0
    v_mov_b32 v97, 0
    v_mov_b32 v98, 0
    v_mov_b32 v99, 0
    v_mov_b32 v100, 0
    v_mov_b32 v101, 0
    v_mov_b32 v102, 0
    v_mov_b32 v103, 0
    v_mov_b32 v104, 0
    v_mov_b32 v105, 0
    v_mov_b32 v106, 0
    v_mov_b32 v107, 0
    v_mov_b32 v108, 0
    v_mov_b32 v109, 0
    v_mov_b32 v110, 0
    v_mov_b32 v111, 0
    v_mov_b32 v112, 0
    v_mov_b32 v113, 0
    v_mov_b32 v114, 0
    v_mov_b32 v115, 0
    v_mov_b32 v116, 0
    v_mov_b32 v117, 0
    v_mov_b32 v118, 0
    v_mov_b32 v119, 0
    v_mov_b32 v120, 0
    v_mov_b32 v121, 0
    v_mov_b32 v122, 0
    v_mov_b32 v123, 0
    v_mov_b32 v124, 0
    v_mov_b32 v125, 0
    v_mov_b32 v126, 0
    v_mov_b32 v127, 0
    s_mov_b32 s44, 0
L_slow_loop:
    s_add_u32 m0, s43, 0
    s_add_u32 s39, s44, 0
    buffer_load_dwordx4 v152, s[16:19], s39 offen lds
    buffer_load_dwordx4 v153, s[16:19], s39 offen offset:1024 lds
    buffer_load_dwordx4 v154, s[16:19], s39 offen offset:2048 lds
    buffer_load_dwordx4 v155, s[16:19], s39 offen offset:3072 lds
    s_add_u32 m0, s43, 4096
    s_add_u32 s39, s44, 4096
    buffer_load_dwordx4 v152, s[16:19], s39 offen lds
    buffer_load_dwordx4 v153, s[16:19], s39 offen offset:1024 lds
    buffer_load_dwordx4 v154, s[16:19], s39 offen offset:2048 lds
    buffer_load_dwordx4 v155, s[16:19], s39 offen offset:3072 lds
    s_waitcnt vmcnt(0)
    ds_read_b128 a[64:67], v224 offset:0
    ds_read_b128 a[68:71], v225 offset:0
    ds_read_b128 a[72:75], v226 offset:0
    ds_read_b128 a[76:79], v227 offset:0
    ds_read_b128 a[80:83], v224 offset:4096
    ds_read_b128 a[84:87], v225 offset:4096
    ds_read_b128 a[88:91], v226 offset:4096
    ds_read_b128 a[92:95], v227 offset:4096
    s_waitcnt lgkmcnt(0)
    v_mfma_f32_16x16x32_bf16 v[160:163], a[64:67], a[0:3], v[192:195]
    v_mfma_f32_16x16x32_bf16 v[160:163], a[68:71], a[4:7], v[160:163]
    v_mfma_f32_16x16x32_bf16 v[160:163], a[72:75], a[8:11], v[160:163]
    v_mfma_f32_16x16x32_bf16 v[160:163], a[76:79], a[12:15], v[160:163]
    v_mfma_f32_16x16x32_bf16 v[164:167], a[64:67], a[16:19], v[196:199]
    v_mfma_f32_16x16x32_bf16 v[164:167], a[68:71], a[20:23], v[164:167]
    v_mfma_f32_16x16x32_bf16 v[164:167], a[72:75], a[24:27], v[164:167]
    v_mfma_f32_16x16x32_bf16 v[164:167], a[76:79], a[28:31], v[164:167]
    v_mfma_f32_16x16x32_bf16 v[168:171], a[64:67], a[32:35], v[200:203]
    v_mfma_f32_16x16x32_bf16 v[168:171], a[68:71], a[36:39], v[168:171]
    v_mfma_f32_16x16x32_bf16 v[168:171], a[72:75], a[40:43], v[168:171]
    v_mfma_f32_16x16x32_bf16 v[168:171], a[76:79], a[44:47], v[168:171]
    v_mfma_f32_16x16x32_bf16 v[172:175], a[64:67], a[48:51], v[204:207]
    v_mfma_f32_16x16x32_bf16 v[172:175], a[68:71], a[52:55], v[172:175]
    v_mfma_f32_16x16x32_bf16 v[172:175], a[72:75], a[56:59], v[172:175]
    v_mfma_f32_16x16x32_bf16 v[172:175], a[76:79], a[60:63], v[172:175]
    v_mfma_f32_16x16x32_bf16 v[176:179], a[80:83], a[0:3], v[192:195]
    v_mfma_f32_16x16x32_bf16 v[176:179], a[84:87], a[4:7], v[176:179]
    v_mfma_f32_16x16x32_bf16 v[176:179], a[88:91], a[8:11], v[176:179]
    v_mfma_f32_16x16x32_bf16 v[176:179], a[92:95], a[12:15], v[176:179]
    v_mfma_f32_16x16x32_bf16 v[180:183], a[80:83], a[16:19], v[196:199]
    v_mfma_f32_16x16x32_bf16 v[180:183], a[84:87], a[20:23], v[180:183]
    v_mfma_f32_16x16x32_bf16 v[180:183], a[88:91], a[24:27], v[180:183]
    v_mfma_f32_16x16x32_bf16 v[180:183], a[92:95], a[28:31], v[180:183]
    v_mfma_f32_16x16x32_bf16 v[184:187], a[80:83], a[32:35], v[200:203]
    v_mfma_f32_16x16x32_bf16 v[184:187], a[84:87], a[36:39], v[184:187]
    v_mfma_f32_16x16x32_bf16 v[184:187], a[88:91], a[40:43], v[184:187]
    v_mfma_f32_16x16x32_bf16 v[184:187], a[92:95], a[44:47], v[184:187]
    v_mfma_f32_16x16x32_bf16 v[188:191], a[80:83], a[48:51], v[204:207]
    v_mfma_f32_16x16x32_bf16 v[188:191], a[84:87], a[52:55], v[188:191]
    v_mfma_f32_16x16x32_bf16 v[188:191], a[88:91], a[56:59], v[188:191]
    v_mfma_f32_16x16x32_bf16 v[188:191], a[92:95], a[60:63], v[188:191]
    s_nop 7
    v_max3_f32 v238, v160, v161, v162
    v_max3_f32 v238, v238, v163, v176
    v_max3_f32 v238, v238, v177, v178
    v_max3_f32 v238, v238, v179, 0
    v_mov_b32 v239, v238
    s_nop 1
    v_permlane16_swap_b32 v238, v239
    s_nop 0
    v_max_f32 v238, v238, v239
    v_mov_b32 v239, v238
    s_nop 1
    v_permlane32_swap_b32 v238, v239
    s_nop 0
    v_max_f32 v238, v238, v239
    v_sub_f32 v240, 0, v238
    v_exp_f32 v240, v240
    v_sub_f32 v192, v192, v238
    v_sub_f32 v193, v193, v238
    v_sub_f32 v194, v194, v238
    v_sub_f32 v195, v195, v238
    v_sub_f32 v160, v160, v238
    v_sub_f32 v161, v161, v238
    v_sub_f32 v162, v162, v238
    v_sub_f32 v163, v163, v238
    v_sub_f32 v176, v176, v238
    v_sub_f32 v177, v177, v238
    v_sub_f32 v178, v178, v238
    v_sub_f32 v179, v179, v238
    v_mul_f32 v0, v240, v0
    v_mul_f32 v1, v240, v1
    v_mul_f32 v2, v240, v2
    v_mul_f32 v3, v240, v3
    v_mul_f32 v4, v240, v4
    v_mul_f32 v5, v240, v5
    v_mul_f32 v6, v240, v6
    v_mul_f32 v7, v240, v7
    v_mul_f32 v8, v240, v8
    v_mul_f32 v9, v240, v9
    v_mul_f32 v10, v240, v10
    v_mul_f32 v11, v240, v11
    v_mul_f32 v12, v240, v12
    v_mul_f32 v13, v240, v13
    v_mul_f32 v14, v240, v14
    v_mul_f32 v15, v240, v15
    v_mul_f32 v64, v240, v64
    v_mul_f32 v65, v240, v65
    v_mul_f32 v66, v240, v66
    v_mul_f32 v67, v240, v67
    v_mul_f32 v68, v240, v68
    v_mul_f32 v69, v240, v69
    v_mul_f32 v70, v240, v70
    v_mul_f32 v71, v240, v71
    v_mul_f32 v72, v240, v72
    v_mul_f32 v73, v240, v73
    v_mul_f32 v74, v240, v74
    v_mul_f32 v75, v240, v75
    v_mul_f32 v76, v240, v76
    v_mul_f32 v77, v240, v77
    v_mul_f32 v78, v240, v78
    v_mul_f32 v79, v240, v79
    v_accvgpr_read_b32 v241, a192
    v_mul_f32 v241, v240, v241
    v_accvgpr_write_b32 a192, v241
    v_accvgpr_write_b32 a193, v241
    v_accvgpr_write_b32 a194, v241
    v_accvgpr_write_b32 a195, v241
    v_exp_f32 v160, v160
    v_exp_f32 v161, v161
    v_exp_f32 v162, v162
    v_exp_f32 v163, v163
    v_cvt_pk_bf16_f32 v128, v160, v161
    v_cvt_pk_bf16_f32 v129, v162, v163
    v_exp_f32 v176, v176
    v_exp_f32 v177, v177
    v_exp_f32 v178, v178
    v_exp_f32 v179, v179
    v_cvt_pk_bf16_f32 v130, v176, v177
    v_cvt_pk_bf16_f32 v131, v178, v179
    v_max3_f32 v238, v164, v165, v166
    v_max3_f32 v238, v238, v167, v180
    v_max3_f32 v238, v238, v181, v182
    v_max3_f32 v238, v238, v183, 0
    v_mov_b32 v239, v238
    s_nop 1
    v_permlane16_swap_b32 v238, v239
    s_nop 0
    v_max_f32 v238, v238, v239
    v_mov_b32 v239, v238
    s_nop 1
    v_permlane32_swap_b32 v238, v239
    s_nop 0
    v_max_f32 v238, v238, v239
    v_sub_f32 v240, 0, v238
    v_exp_f32 v240, v240
    v_sub_f32 v196, v196, v238
    v_sub_f32 v197, v197, v238
    v_sub_f32 v198, v198, v238
    v_sub_f32 v199, v199, v238
    v_sub_f32 v164, v164, v238
    v_sub_f32 v165, v165, v238
    v_sub_f32 v166, v166, v238
    v_sub_f32 v167, v167, v238
    v_sub_f32 v180, v180, v238
    v_sub_f32 v181, v181, v238
    v_sub_f32 v182, v182, v238
    v_sub_f32 v183, v183, v238
    v_mul_f32 v16, v240, v16
    v_mul_f32 v17, v240, v17
    v_mul_f32 v18, v240, v18
    v_mul_f32 v19, v240, v19
    v_mul_f32 v20, v240, v20
    v_mul_f32 v21, v240, v21
    v_mul_f32 v22, v240, v22
    v_mul_f32 v23, v240, v23
    v_mul_f32 v24, v240, v24
    v_mul_f32 v25, v240, v25
    v_mul_f32 v26, v240, v26
    v_mul_f32 v27, v240, v27
    v_mul_f32 v28, v240, v28
    v_mul_f32 v29, v240, v29
    v_mul_f32 v30, v240, v30
    v_mul_f32 v31, v240, v31
    v_mul_f32 v80, v240, v80
    v_mul_f32 v81, v240, v81
    v_mul_f32 v82, v240, v82
    v_mul_f32 v83, v240, v83
    v_mul_f32 v84, v240, v84
    v_mul_f32 v85, v240, v85
    v_mul_f32 v86, v240, v86
    v_mul_f32 v87, v240, v87
    v_mul_f32 v88, v240, v88
    v_mul_f32 v89, v240, v89
    v_mul_f32 v90, v240, v90
    v_mul_f32 v91, v240, v91
    v_mul_f32 v92, v240, v92
    v_mul_f32 v93, v240, v93
    v_mul_f32 v94, v240, v94
    v_mul_f32 v95, v240, v95
    v_accvgpr_read_b32 v241, a196
    v_mul_f32 v241, v240, v241
    v_accvgpr_write_b32 a196, v241
    v_accvgpr_write_b32 a197, v241
    v_accvgpr_write_b32 a198, v241
    v_accvgpr_write_b32 a199, v241
    v_exp_f32 v164, v164
    v_exp_f32 v165, v165
    v_exp_f32 v166, v166
    v_exp_f32 v167, v167
    v_cvt_pk_bf16_f32 v132, v164, v165
    v_cvt_pk_bf16_f32 v133, v166, v167
    v_exp_f32 v180, v180
    v_exp_f32 v181, v181
    v_exp_f32 v182, v182
    v_exp_f32 v183, v183
    v_cvt_pk_bf16_f32 v134, v180, v181
    v_cvt_pk_bf16_f32 v135, v182, v183
    v_max3_f32 v238, v168, v169, v170
    v_max3_f32 v238, v238, v171, v184
    v_max3_f32 v238, v238, v185, v186
    v_max3_f32 v238, v238, v187, 0
    v_mov_b32 v239, v238
    s_nop 1
    v_permlane16_swap_b32 v238, v239
    s_nop 0
    v_max_f32 v238, v238, v239
    v_mov_b32 v239, v238
    s_nop 1
    v_permlane32_swap_b32 v238, v239
    s_nop 0
    v_max_f32 v238, v238, v239
    v_sub_f32 v240, 0, v238
    v_exp_f32 v240, v240
    v_sub_f32 v200, v200, v238
    v_sub_f32 v201, v201, v238
    v_sub_f32 v202, v202, v238
    v_sub_f32 v203, v203, v238
    v_sub_f32 v168, v168, v238
    v_sub_f32 v169, v169, v238
    v_sub_f32 v170, v170, v238
    v_sub_f32 v171, v171, v238
    v_sub_f32 v184, v184, v238
    v_sub_f32 v185, v185, v238
    v_sub_f32 v186, v186, v238
    v_sub_f32 v187, v187, v238
    v_mul_f32 v32, v240, v32
    v_mul_f32 v33, v240, v33
    v_mul_f32 v34, v240, v34
    v_mul_f32 v35, v240, v35
    v_mul_f32 v36, v240, v36
    v_mul_f32 v37, v240, v37
    v_mul_f32 v38, v240, v38
    v_mul_f32 v39, v240, v39
    v_mul_f32 v40, v240, v40
    v_mul_f32 v41, v240, v41
    v_mul_f32 v42, v240, v42
    v_mul_f32 v43, v240, v43
    v_mul_f32 v44, v240, v44
    v_mul_f32 v45, v240, v45
    v_mul_f32 v46, v240, v46
    v_mul_f32 v47, v240, v47
    v_mul_f32 v96, v240, v96
    v_mul_f32 v97, v240, v97
    v_mul_f32 v98, v240, v98
    v_mul_f32 v99, v240, v99
    v_mul_f32 v100, v240, v100
    v_mul_f32 v101, v240, v101
    v_mul_f32 v102, v240, v102
    v_mul_f32 v103, v240, v103
    v_mul_f32 v104, v240, v104
    v_mul_f32 v105, v240, v105
    v_mul_f32 v106, v240, v106
    v_mul_f32 v107, v240, v107
    v_mul_f32 v108, v240, v108
    v_mul_f32 v109, v240, v109
    v_mul_f32 v110, v240, v110
    v_mul_f32 v111, v240, v111
    v_accvgpr_read_b32 v241, a200
    v_mul_f32 v241, v240, v241
    v_accvgpr_write_b32 a200, v241
    v_accvgpr_write_b32 a201, v241
    v_accvgpr_write_b32 a202, v241
    v_accvgpr_write_b32 a203, v241
    v_exp_f32 v168, v168
    v_exp_f32 v169, v169
    v_exp_f32 v170, v170
    v_exp_f32 v171, v171
    v_cvt_pk_bf16_f32 v136, v168, v169
    v_cvt_pk_bf16_f32 v137, v170, v171
    v_exp_f32 v184, v184
    v_exp_f32 v185, v185
    v_exp_f32 v186, v186
    v_exp_f32 v187, v187
    v_cvt_pk_bf16_f32 v138, v184, v185
    v_cvt_pk_bf16_f32 v139, v186, v187
    v_max3_f32 v238, v172, v173, v174
    v_max3_f32 v238, v238, v175, v188
    v_max3_f32 v238, v238, v189, v190
    v_max3_f32 v238, v238, v191, 0
    v_mov_b32 v239, v238
    s_nop 1
    v_permlane16_swap_b32 v238, v239
    s_nop 0
    v_max_f32 v238, v238, v239
    v_mov_b32 v239, v238
    s_nop 1
    v_permlane32_swap_b32 v238, v239
    s_nop 0
    v_max_f32 v238, v238, v239
    v_sub_f32 v240, 0, v238
    v_exp_f32 v240, v240
    v_sub_f32 v204, v204, v238
    v_sub_f32 v205, v205, v238
    v_sub_f32 v206, v206, v238
    v_sub_f32 v207, v207, v238
    v_sub_f32 v172, v172, v238
    v_sub_f32 v173, v173, v238
    v_sub_f32 v174, v174, v238
    v_sub_f32 v175, v175, v238
    v_sub_f32 v188, v188, v238
    v_sub_f32 v189, v189, v238
    v_sub_f32 v190, v190, v238
    v_sub_f32 v191, v191, v238
    v_mul_f32 v48, v240, v48
    v_mul_f32 v49, v240, v49
    v_mul_f32 v50, v240, v50
    v_mul_f32 v51, v240, v51
    v_mul_f32 v52, v240, v52
    v_mul_f32 v53, v240, v53
    v_mul_f32 v54, v240, v54
    v_mul_f32 v55, v240, v55
    v_mul_f32 v56, v240, v56
    v_mul_f32 v57, v240, v57
    v_mul_f32 v58, v240, v58
    v_mul_f32 v59, v240, v59
    v_mul_f32 v60, v240, v60
    v_mul_f32 v61, v240, v61
    v_mul_f32 v62, v240, v62
    v_mul_f32 v63, v240, v63
    v_mul_f32 v112, v240, v112
    v_mul_f32 v113, v240, v113
    v_mul_f32 v114, v240, v114
    v_mul_f32 v115, v240, v115
    v_mul_f32 v116, v240, v116
    v_mul_f32 v117, v240, v117
    v_mul_f32 v118, v240, v118
    v_mul_f32 v119, v240, v119
    v_mul_f32 v120, v240, v120
    v_mul_f32 v121, v240, v121
    v_mul_f32 v122, v240, v122
    v_mul_f32 v123, v240, v123
    v_mul_f32 v124, v240, v124
    v_mul_f32 v125, v240, v125
    v_mul_f32 v126, v240, v126
    v_mul_f32 v127, v240, v127
    v_accvgpr_read_b32 v241, a204
    v_mul_f32 v241, v240, v241
    v_accvgpr_write_b32 a204, v241
    v_accvgpr_write_b32 a205, v241
    v_accvgpr_write_b32 a206, v241
    v_accvgpr_write_b32 a207, v241
    v_exp_f32 v172, v172
    v_exp_f32 v173, v173
    v_exp_f32 v174, v174
    v_exp_f32 v175, v175
    v_cvt_pk_bf16_f32 v140, v172, v173
    v_cvt_pk_bf16_f32 v141, v174, v175
    v_exp_f32 v188, v188
    v_exp_f32 v189, v189
    v_exp_f32 v190, v190
    v_exp_f32 v191, v191
    v_cvt_pk_bf16_f32 v142, v188, v189
    v_cvt_pk_bf16_f32 v143, v190, v191
    ds_read_b64_tr_b16 a[64:65], v144 offset:0
    ds_read_b64_tr_b16 a[66:67], v144 offset:2048
    ds_read_b64_tr_b16 a[68:69], v145 offset:0
    ds_read_b64_tr_b16 a[70:71], v145 offset:2048
    ds_read_b64_tr_b16 a[72:73], v146 offset:0
    ds_read_b64_tr_b16 a[74:75], v146 offset:2048
    ds_read_b64_tr_b16 a[76:77], v147 offset:0
    ds_read_b64_tr_b16 a[78:79], v147 offset:2048
    s_waitcnt lgkmcnt(0)
    ds_read_b64_tr_b16 a[80:81], v148 offset:0
    ds_read_b64_tr_b16 a[82:83], v148 offset:2048
    ds_read_b64_tr_b16 a[84:85], v149 offset:0
    ds_read_b64_tr_b16 a[86:87], v149 offset:2048
    ds_read_b64_tr_b16 a[88:89], v150 offset:0
    ds_read_b64_tr_b16 a[90:91], v150 offset:2048
    ds_read_b64_tr_b16 a[92:93], v151 offset:0
    ds_read_b64_tr_b16 a[94:95], v151 offset:2048
    v_mfma_f32_16x16x32_bf16 a[192:195], a[208:211], v[128:131], a[192:195]
    v_mfma_f32_16x16x32_bf16 a[196:199], a[208:211], v[132:135], a[196:199]
    v_mfma_f32_16x16x32_bf16 a[200:203], a[208:211], v[136:139], a[200:203]
    v_mfma_f32_16x16x32_bf16 a[204:207], a[208:211], v[140:143], a[204:207]
    s_waitcnt lgkmcnt(0)
    v_mfma_f32_16x16x32_bf16 v[0:3], a[64:67], v[128:131], v[0:3]
    v_mfma_f32_16x16x32_bf16 v[16:19], a[64:67], v[132:135], v[16:19]
    v_mfma_f32_16x16x32_bf16 v[32:35], a[64:67], v[136:139], v[32:35]
    v_mfma_f32_16x16x32_bf16 v[48:51], a[64:67], v[140:143], v[48:51]
    v_mfma_f32_16x16x32_bf16 v[4:7], a[68:71], v[128:131], v[4:7]
    v_mfma_f32_16x16x32_bf16 v[20:23], a[68:71], v[132:135], v[20:23]
    v_mfma_f32_16x16x32_bf16 v[36:39], a[68:71], v[136:139], v[36:39]
    v_mfma_f32_16x16x32_bf16 v[52:55], a[68:71], v[140:143], v[52:55]
    v_mfma_f32_16x16x32_bf16 v[8:11], a[72:75], v[128:131], v[8:11]
    v_mfma_f32_16x16x32_bf16 v[24:27], a[72:75], v[132:135], v[24:27]
    v_mfma_f32_16x16x32_bf16 v[40:43], a[72:75], v[136:139], v[40:43]
    v_mfma_f32_16x16x32_bf16 v[56:59], a[72:75], v[140:143], v[56:59]
    v_mfma_f32_16x16x32_bf16 v[12:15], a[76:79], v[128:131], v[12:15]
    v_mfma_f32_16x16x32_bf16 v[28:31], a[76:79], v[132:135], v[28:31]
    v_mfma_f32_16x16x32_bf16 v[44:47], a[76:79], v[136:139], v[44:47]
    v_mfma_f32_16x16x32_bf16 v[60:63], a[76:79], v[140:143], v[60:63]
    v_mfma_f32_16x16x32_bf16 v[64:67], a[80:83], v[128:131], v[64:67]
    v_mfma_f32_16x16x32_bf16 v[80:83], a[80:83], v[132:135], v[80:83]
    v_mfma_f32_16x16x32_bf16 v[96:99], a[80:83], v[136:139], v[96:99]
    v_mfma_f32_16x16x32_bf16 v[112:115], a[80:83], v[140:143], v[112:115]
    v_mfma_f32_16x16x32_bf16 v[68:71], a[84:87], v[128:131], v[68:71]
    v_mfma_f32_16x16x32_bf16 v[84:87], a[84:87], v[132:135], v[84:87]
    v_mfma_f32_16x16x32_bf16 v[100:103], a[84:87], v[136:139], v[100:103]
    v_mfma_f32_16x16x32_bf16 v[116:119], a[84:87], v[140:143], v[116:119]
    v_mfma_f32_16x16x32_bf16 v[72:75], a[88:91], v[128:131], v[72:75]
    v_mfma_f32_16x16x32_bf16 v[88:91], a[88:91], v[132:135], v[88:91]
    v_mfma_f32_16x16x32_bf16 v[104:107], a[88:91], v[136:139], v[104:107]
    v_mfma_f32_16x16x32_bf16 v[120:123], a[88:91], v[140:143], v[120:123]
    v_mfma_f32_16x16x32_bf16 v[76:79], a[92:95], v[128:131], v[76:79]
    v_mfma_f32_16x16x32_bf16 v[92:95], a[92:95], v[132:135], v[92:95]
    v_mfma_f32_16x16x32_bf16 v[108:111], a[92:95], v[136:139], v[108:111]
    v_mfma_f32_16x16x32_bf16 v[124:127], a[92:95], v[140:143], v[124:127]
    v_add_u32 v144, 0x1000, v144
    v_add_u32 v145, 0x1000, v145
    v_add_u32 v146, 0x1000, v146
    v_add_u32 v147, 0x1000, v147
    v_add_u32 v148, 0x1000, v148
    v_add_u32 v149, 0x1000, v149
    v_add_u32 v150, 0x1000, v150
    v_add_u32 v151, 0x1000, v151
    s_add_u32 s44, s44, 8192
    s_cmp_lt_u32 s44, 131072
    s_cbranch_scc1 L_slow_loop
    v_and_b32 v240, 15, v232
    v_and_b32 v238, 7, v232
    v_lshrrev_b32 v241, 5, v232
    v_xor_b32 v241, v241, v238
    v_lshlrev_b32 v241, 4, v241
    v_lshl_or_b32 v241, v240, 7, v241
    v_bfe_u32 v240, v232, 4, 1
    v_lshl_or_b32 v241, v240, 3, v241
    v_add_u32 v246, s43, v241
    v_xor_b32 v247, 32, v246
    v_xor_b32 v248, 64, v246
    v_xor_b32 v249, 96, v246
    v_lshrrev_b32 v240, 3, v232
    v_xor_b32 v241, v238, v240
    v_lshlrev_b32 v241, 4, v241
    v_lshl_or_b32 v239, v240, 7, v241
    v_add_u32 v239, s43, v239
    v_lshlrev_b32 v238, 4, v238
    v_lshl_or_b32 v240, v240, 8, v238
    v_accvgpr_read_b32 v242, a192
    v_accvgpr_read_b32 v243, a196
    v_accvgpr_read_b32 v244, a200
    v_accvgpr_read_b32 v245, a204
    v_add_f32 v228, v242, v243
    v_add_f32 v229, v244, v245
    v_add_f32 v228, v228, v229
    v_rcp_f32 v242, v242
    v_rcp_f32 v243, v243
    v_rcp_f32 v244, v244
    v_rcp_f32 v245, v245
    s_nop 1
    v_mul_f32 v0, v242, v0
    v_mul_f32 v1, v242, v1
    v_mul_f32 v2, v242, v2
    v_mul_f32 v3, v242, v3
    v_cvt_pk_bf16_f32 v0, v0, v1
    v_cvt_pk_bf16_f32 v1, v2, v3
    ds_write_b64 v246, v[0:1] offset:0
    v_mul_f32 v4, v242, v4
    v_mul_f32 v5, v242, v5
    v_mul_f32 v6, v242, v6
    v_mul_f32 v7, v242, v7
    v_cvt_pk_bf16_f32 v4, v4, v5
    v_cvt_pk_bf16_f32 v5, v6, v7
    ds_write_b64 v247, v[4:5] offset:0
    v_mul_f32 v8, v242, v8
    v_mul_f32 v9, v242, v9
    v_mul_f32 v10, v242, v10
    v_mul_f32 v11, v242, v11
    v_cvt_pk_bf16_f32 v8, v8, v9
    v_cvt_pk_bf16_f32 v9, v10, v11
    ds_write_b64 v248, v[8:9] offset:0
    v_mul_f32 v12, v242, v12
    v_mul_f32 v13, v242, v13
    v_mul_f32 v14, v242, v14
    v_mul_f32 v15, v242, v15
    v_cvt_pk_bf16_f32 v12, v12, v13
    v_cvt_pk_bf16_f32 v13, v14, v15
    ds_write_b64 v249, v[12:13] offset:0
    ds_read_b128 a[64:67], v239 offset:0
    ds_read_b128 a[68:71], v239 offset:1024
    s_waitcnt lgkmcnt(1)
    buffer_store_dwordx4 a[64:67], v240, s[24:27], s31 offen
    s_waitcnt lgkmcnt(0)
    buffer_store_dwordx4 a[68:71], v240, s[24:27], s31 offen offset:2048
    s_waitcnt vmcnt(0)
    v_mul_f32 v16, v243, v16
    v_mul_f32 v17, v243, v17
    v_mul_f32 v18, v243, v18
    v_mul_f32 v19, v243, v19
    v_cvt_pk_bf16_f32 v16, v16, v17
    v_cvt_pk_bf16_f32 v17, v18, v19
    ds_write_b64 v246, v[16:17] offset:2048
    v_mul_f32 v20, v243, v20
    v_mul_f32 v21, v243, v21
    v_mul_f32 v22, v243, v22
    v_mul_f32 v23, v243, v23
    v_cvt_pk_bf16_f32 v20, v20, v21
    v_cvt_pk_bf16_f32 v21, v22, v23
    ds_write_b64 v247, v[20:21] offset:2048
    v_mul_f32 v24, v243, v24
    v_mul_f32 v25, v243, v25
    v_mul_f32 v26, v243, v26
    v_mul_f32 v27, v243, v27
    v_cvt_pk_bf16_f32 v24, v24, v25
    v_cvt_pk_bf16_f32 v25, v26, v27
    ds_write_b64 v248, v[24:25] offset:2048
    v_mul_f32 v28, v243, v28
    v_mul_f32 v29, v243, v29
    v_mul_f32 v30, v243, v30
    v_mul_f32 v31, v243, v31
    v_cvt_pk_bf16_f32 v28, v28, v29
    v_cvt_pk_bf16_f32 v29, v30, v31
    ds_write_b64 v249, v[28:29] offset:2048
    ds_read_b128 a[64:67], v239 offset:2048
    ds_read_b128 a[68:71], v239 offset:3072
    s_waitcnt lgkmcnt(1)
    buffer_store_dwordx4 a[64:67], v240, s[24:27], s34 offen
    s_waitcnt lgkmcnt(0)
    buffer_store_dwordx4 a[68:71], v240, s[24:27], s34 offen offset:2048
    s_waitcnt vmcnt(0)
    v_mul_f32 v32, v244, v32
    v_mul_f32 v33, v244, v33
    v_mul_f32 v34, v244, v34
    v_mul_f32 v35, v244, v35
    v_cvt_pk_bf16_f32 v32, v32, v33
    v_cvt_pk_bf16_f32 v33, v34, v35
    ds_write_b64 v246, v[32:33] offset:4096
    v_mul_f32 v36, v244, v36
    v_mul_f32 v37, v244, v37
    v_mul_f32 v38, v244, v38
    v_mul_f32 v39, v244, v39
    v_cvt_pk_bf16_f32 v36, v36, v37
    v_cvt_pk_bf16_f32 v37, v38, v39
    ds_write_b64 v247, v[36:37] offset:4096
    v_mul_f32 v40, v244, v40
    v_mul_f32 v41, v244, v41
    v_mul_f32 v42, v244, v42
    v_mul_f32 v43, v244, v43
    v_cvt_pk_bf16_f32 v40, v40, v41
    v_cvt_pk_bf16_f32 v41, v42, v43
    ds_write_b64 v248, v[40:41] offset:4096
    v_mul_f32 v44, v244, v44
    v_mul_f32 v45, v244, v45
    v_mul_f32 v46, v244, v46
    v_mul_f32 v47, v244, v47
    v_cvt_pk_bf16_f32 v44, v44, v45
    v_cvt_pk_bf16_f32 v45, v46, v47
    ds_write_b64 v249, v[44:45] offset:4096
    ds_read_b128 a[64:67], v239 offset:4096
    ds_read_b128 a[68:71], v239 offset:5120
    s_waitcnt lgkmcnt(1)
    buffer_store_dwordx4 a[64:67], v240, s[24:27], s35 offen
    s_waitcnt lgkmcnt(0)
    buffer_store_dwordx4 a[68:71], v240, s[24:27], s35 offen offset:2048
    s_waitcnt vmcnt(0)
    v_mul_f32 v48, v245, v48
    v_mul_f32 v49, v245, v49
    v_mul_f32 v50, v245, v50
    v_mul_f32 v51, v245, v51
    v_cvt_pk_bf16_f32 v48, v48, v49
    v_cvt_pk_bf16_f32 v49, v50, v51
    ds_write_b64 v246, v[48:49] offset:6144
    v_mul_f32 v52, v245, v52
    v_mul_f32 v53, v245, v53
    v_mul_f32 v54, v245, v54
    v_mul_f32 v55, v245, v55
    v_cvt_pk_bf16_f32 v52, v52, v53
    v_cvt_pk_bf16_f32 v53, v54, v55
    ds_write_b64 v247, v[52:53] offset:6144
    v_mul_f32 v56, v245, v56
    v_mul_f32 v57, v245, v57
    v_mul_f32 v58, v245, v58
    v_mul_f32 v59, v245, v59
    v_cvt_pk_bf16_f32 v56, v56, v57
    v_cvt_pk_bf16_f32 v57, v58, v59
    ds_write_b64 v248, v[56:57] offset:6144
    v_mul_f32 v60, v245, v60
    v_mul_f32 v61, v245, v61
    v_mul_f32 v62, v245, v62
    v_mul_f32 v63, v245, v63
    v_cvt_pk_bf16_f32 v60, v60, v61
    v_cvt_pk_bf16_f32 v61, v62, v63
    ds_write_b64 v249, v[60:61] offset:6144
    ds_read_b128 a[64:67], v239 offset:6144
    ds_read_b128 a[68:71], v239 offset:7168
    s_waitcnt lgkmcnt(1)
    buffer_store_dwordx4 a[64:67], v240, s[24:27], s36 offen
    s_waitcnt lgkmcnt(0)
    buffer_store_dwordx4 a[68:71], v240, s[24:27], s36 offen offset:2048
    s_waitcnt vmcnt(0)
    v_mul_f32 v64, v242, v64
    v_mul_f32 v65, v242, v65
    v_mul_f32 v66, v242, v66
    v_mul_f32 v67, v242, v67
    v_cvt_pk_bf16_f32 v64, v64, v65
    v_cvt_pk_bf16_f32 v65, v66, v67
    ds_write_b64 v246, v[64:65] offset:0
    v_mul_f32 v68, v242, v68
    v_mul_f32 v69, v242, v69
    v_mul_f32 v70, v242, v70
    v_mul_f32 v71, v242, v71
    v_cvt_pk_bf16_f32 v68, v68, v69
    v_cvt_pk_bf16_f32 v69, v70, v71
    ds_write_b64 v247, v[68:69] offset:0
    v_mul_f32 v72, v242, v72
    v_mul_f32 v73, v242, v73
    v_mul_f32 v74, v242, v74
    v_mul_f32 v75, v242, v75
    v_cvt_pk_bf16_f32 v72, v72, v73
    v_cvt_pk_bf16_f32 v73, v74, v75
    ds_write_b64 v248, v[72:73] offset:0
    v_mul_f32 v76, v242, v76
    v_mul_f32 v77, v242, v77
    v_mul_f32 v78, v242, v78
    v_mul_f32 v79, v242, v79
    v_cvt_pk_bf16_f32 v76, v76, v77
    v_cvt_pk_bf16_f32 v77, v78, v79
    ds_write_b64 v249, v[76:77] offset:0
    ds_read_b128 a[64:67], v239 offset:0
    ds_read_b128 a[68:71], v239 offset:1024
    s_waitcnt lgkmcnt(1)
    buffer_store_dwordx4 a[64:67], v240, s[24:27], s31 offen offset:128
    s_waitcnt lgkmcnt(0)
    buffer_store_dwordx4 a[68:71], v240, s[24:27], s31 offen offset:2176
    s_waitcnt vmcnt(0)
    v_mul_f32 v80, v243, v80
    v_mul_f32 v81, v243, v81
    v_mul_f32 v82, v243, v82
    v_mul_f32 v83, v243, v83
    v_cvt_pk_bf16_f32 v80, v80, v81
    v_cvt_pk_bf16_f32 v81, v82, v83
    ds_write_b64 v246, v[80:81] offset:2048
    v_mul_f32 v84, v243, v84
    v_mul_f32 v85, v243, v85
    v_mul_f32 v86, v243, v86
    v_mul_f32 v87, v243, v87
    v_cvt_pk_bf16_f32 v84, v84, v85
    v_cvt_pk_bf16_f32 v85, v86, v87
    ds_write_b64 v247, v[84:85] offset:2048
    v_mul_f32 v88, v243, v88
    v_mul_f32 v89, v243, v89
    v_mul_f32 v90, v243, v90
    v_mul_f32 v91, v243, v91
    v_cvt_pk_bf16_f32 v88, v88, v89
    v_cvt_pk_bf16_f32 v89, v90, v91
    ds_write_b64 v248, v[88:89] offset:2048
    v_mul_f32 v92, v243, v92
    v_mul_f32 v93, v243, v93
    v_mul_f32 v94, v243, v94
    v_mul_f32 v95, v243, v95
    v_cvt_pk_bf16_f32 v92, v92, v93
    v_cvt_pk_bf16_f32 v93, v94, v95
    ds_write_b64 v249, v[92:93] offset:2048
    ds_read_b128 a[64:67], v239 offset:2048
    ds_read_b128 a[68:71], v239 offset:3072
    s_waitcnt lgkmcnt(1)
    buffer_store_dwordx4 a[64:67], v240, s[24:27], s34 offen offset:128
    s_waitcnt lgkmcnt(0)
    buffer_store_dwordx4 a[68:71], v240, s[24:27], s34 offen offset:2176
    s_waitcnt vmcnt(0)
    v_mul_f32 v96, v244, v96
    v_mul_f32 v97, v244, v97
    v_mul_f32 v98, v244, v98
    v_mul_f32 v99, v244, v99
    v_cvt_pk_bf16_f32 v96, v96, v97
    v_cvt_pk_bf16_f32 v97, v98, v99
    ds_write_b64 v246, v[96:97] offset:4096
    v_mul_f32 v100, v244, v100
    v_mul_f32 v101, v244, v101
    v_mul_f32 v102, v244, v102
    v_mul_f32 v103, v244, v103
    v_cvt_pk_bf16_f32 v100, v100, v101
    v_cvt_pk_bf16_f32 v101, v102, v103
    ds_write_b64 v247, v[100:101] offset:4096
    v_mul_f32 v104, v244, v104
    v_mul_f32 v105, v244, v105
    v_mul_f32 v106, v244, v106
    v_mul_f32 v107, v244, v107
    v_cvt_pk_bf16_f32 v104, v104, v105
    v_cvt_pk_bf16_f32 v105, v106, v107
    ds_write_b64 v248, v[104:105] offset:4096
    v_mul_f32 v108, v244, v108
    v_mul_f32 v109, v244, v109
    v_mul_f32 v110, v244, v110
    v_mul_f32 v111, v244, v111
    v_cvt_pk_bf16_f32 v108, v108, v109
    v_cvt_pk_bf16_f32 v109, v110, v111
    ds_write_b64 v249, v[108:109] offset:4096
    ds_read_b128 a[64:67], v239 offset:4096
    ds_read_b128 a[68:71], v239 offset:5120
    s_waitcnt lgkmcnt(1)
    buffer_store_dwordx4 a[64:67], v240, s[24:27], s35 offen offset:128
    s_waitcnt lgkmcnt(0)
    buffer_store_dwordx4 a[68:71], v240, s[24:27], s35 offen offset:2176
    s_waitcnt vmcnt(0)
    v_mul_f32 v112, v245, v112
    v_mul_f32 v113, v245, v113
    v_mul_f32 v114, v245, v114
    v_mul_f32 v115, v245, v115
    v_cvt_pk_bf16_f32 v112, v112, v113
    v_cvt_pk_bf16_f32 v113, v114, v115
    ds_write_b64 v246, v[112:113] offset:6144
    v_mul_f32 v116, v245, v116
    v_mul_f32 v117, v245, v117
    v_mul_f32 v118, v245, v118
    v_mul_f32 v119, v245, v119
    v_cvt_pk_bf16_f32 v116, v116, v117
    v_cvt_pk_bf16_f32 v117, v118, v119
    ds_write_b64 v247, v[116:117] offset:6144
    v_mul_f32 v120, v245, v120
    v_mul_f32 v121, v245, v121
    v_mul_f32 v122, v245, v122
    v_mul_f32 v123, v245, v123
    v_cvt_pk_bf16_f32 v120, v120, v121
    v_cvt_pk_bf16_f32 v121, v122, v123
    ds_write_b64 v248, v[120:121] offset:6144
    v_mul_f32 v124, v245, v124
    v_mul_f32 v125, v245, v125
    v_mul_f32 v126, v245, v126
    v_mul_f32 v127, v245, v127
    v_cvt_pk_bf16_f32 v124, v124, v125
    v_cvt_pk_bf16_f32 v125, v126, v127
    ds_write_b64 v249, v[124:125] offset:6144
    ds_read_b128 a[64:67], v239 offset:6144
    ds_read_b128 a[68:71], v239 offset:7168
    s_waitcnt lgkmcnt(1)
    buffer_store_dwordx4 a[64:67], v240, s[24:27], s36 offen offset:128
    s_waitcnt lgkmcnt(0)
    buffer_store_dwordx4 a[68:71], v240, s[24:27], s36 offen offset:2176
    s_waitcnt vmcnt(0)
    s_branch L_done
.section .rodata,"a"
.p2align 6
.amdhsa_kernel standalone__mha_softmax__near_ridge_kernel
  .amdhsa_next_free_vgpr 500
  .amdhsa_next_free_sgpr 72
  .amdhsa_accum_offset 256
  .amdhsa_group_segment_fixed_size 0
  .amdhsa_kernarg_size 48
  .amdhsa_user_sgpr_count 2
  .amdhsa_user_sgpr_kernarg_segment_ptr 1
  .amdhsa_system_sgpr_workgroup_id_x 1
.end_amdhsa_kernel
```
